```python
import torch

def _softmax(x, axis=-1):
    return torch.softmax(x, dim=axis)
def _gelu(x):
    return torch.nn.functional.gelu(x, approximate="tanh")
def _silu(x):
    return torch.nn.functional.silu(x)
def _sigmoid(x):
    return torch.sigmoid(x)
def _layernorm(x, axis=-1, eps=1e-5):
    m = x.mean(dim=axis, keepdim=True)
    v = x.var(dim=axis, keepdim=True, unbiased=False)
    return (x - m) / torch.sqrt(v + eps)
def _scatter_add(tgt, idx, src, axis=0):
    return tgt.clone().index_add_(axis, idx, src)
def _segment_sum(src, seg, n):
    out = torch.zeros((n,) + src.shape[1:], dtype=src.dtype)
    return out.index_add_(0, seg, src)
def _pad(x, pw):
    flat = tuple(v for pair in reversed(pw) for v in pair)
    return torch.nn.functional.pad(x, flat)

kernel_name = 'interleave_layers__ssm_conv_s4d__glu_gated_glu__prompt'

def setup_inputs():

    _w = (lambda a: (lambda t: t.to(torch.bfloat16) if t.is_floating_point() else t)(torch.as_tensor(a)))
    def _A_setup():
        Bsz, L, D, N = 1, 2048, 512, 128
        return {
            "u": _w((lambda *s: torch.randn(*s, dtype=torch.bfloat16) * 0.05)(Bsz, L, D)),
            "log_A_real": _w((lambda *s: torch.randn(*s, dtype=torch.bfloat16) * 3.2)(D, N) * 0.5),
            "A_imag": _w((lambda *s: torch.randn(*s, dtype=torch.bfloat16) * 0.1)(D, N) * 3.14),
            "C_real": _w((lambda *s: torch.randn(*s, dtype=torch.bfloat16) * 0.1)(D, N) / N ** 0.5),
            "C_imag": _w((lambda *s: torch.randn(*s, dtype=torch.bfloat16) * 0.1)(D, N) / N ** 0.5),
            "log_dt": _w((lambda *s: torch.randn(*s, dtype=torch.bfloat16) * 0.1)(D) * 0.5 - 4.0),
            "D_skip": _w((lambda *s: torch.randn(*s, dtype=torch.bfloat16) * 0.1)(D)),
        }
    _A_in = _A_setup()

    def _B_setup():
        B, S, D, F = 1, 2048, 512, 1376
        return {
            "x": _w((lambda *s: torch.randn(*s, dtype=torch.bfloat16) * 0.05)(B, S, D)),
            "w_gate": _w((lambda *s: torch.randn(*s, dtype=torch.bfloat16) * 0.05)(D, F)),
            "w_up": _w((lambda *s: torch.randn(*s, dtype=torch.bfloat16) * 0.05)(D, F)),
            "w_down": _w((lambda *s: torch.randn(*s, dtype=torch.bfloat16) * 0.05)(F, D)),
        }
    _B_in = _B_setup()

    return {
        "A_u": _A_in["u"],
        "A_log_A_real": _A_in["log_A_real"],
        "A_A_imag": _A_in["A_imag"],
        "A_C_real": _A_in["C_real"],
        "A_C_imag": _A_in["C_imag"],
        "A_log_dt": _A_in["log_dt"],
        "A_D_skip": _A_in["D_skip"],
        "B_x": _B_in["x"],
        "B_w_gate": _B_in["w_gate"],
        "B_w_up": _B_in["w_up"],
        "B_w_down": _B_in["w_down"],
    }

def reference(A_u, A_log_A_real, A_A_imag, A_C_real, A_C_imag, A_log_dt, A_D_skip, B_x, B_w_gate, B_w_up, B_w_down):
    def _A_ref(u, log_A_real, A_imag, C_real, C_imag, log_dt, D_skip):
        L = u.shape[1]
        dt = torch.exp(log_dt)
        A = -torch.exp(log_A_real) + 1j * A_imag
        C = (C_real + 1j * C_imag) * dt[:, None]
        pos = (lambda x, dt: x.to(dt))(torch.arange(L), log_dt.dtype)
        P = torch.exp((A * dt[:, None])[:, :, None] * pos[None, None, :])
        K = 2.0 * torch.einsum("dn,dnl->dl", C, P).real
        L2 = 2 * L
        u_t = (lambda x, *d: x.permute(*d))(u, 0, 2, 1)
        Kf = (lambda x, *a, **k: torch.fft.rfft(x.float(), *a, **k))(K, L2)
        Uf = (lambda x, *a, **k: torch.fft.rfft(x.float(), *a, **k))(u_t, L2)
        y = (lambda x, *a, **k: torch.fft.irfft(x, *a, **k).to(torch.bfloat16))(Uf * Kf[None, :, :], L2)[:, :, :L]
        y = (lambda x, *d: x.permute(*d))(y, 0, 2, 1)
        return y + u * D_skip[None, None, :]

    def _B_ref(x, w_gate, w_up, w_down):
        g = torch.einsum("bsd,df->bsf", x, w_gate)
        u = torch.einsum("bsd,df->bsf", x, w_up)
        h = _sigmoid(g) * u
        return torch.einsum("bsf,fd->bsd", h, w_down)

    x = A_u
    x = x + _A_ref(_layernorm(x, axis=-1), A_log_A_real, A_A_imag, A_C_real, A_C_imag, A_log_dt, A_D_skip)
    x = x + _B_ref(_layernorm(x, axis=-1), B_w_gate, B_w_up, B_w_down)
    x = x + _A_ref(_layernorm(x, axis=-1), A_log_A_real, A_A_imag, A_C_real, A_C_imag, A_log_dt, A_D_skip)
    x = x + _B_ref(_layernorm(x, axis=-1), B_w_gate, B_w_up, B_w_down)
    return x
```

```asm
; @launch kernel=f1_kernel grid=(768,1,1) block=(256,1,1) lds=50368
; @launch kernel=mlpa_kernel grid=(256,1,1) block=(512,1,1) lds=163840
; @launch kernel=conv2_kernel grid=(512,1,1) block=(256,1,1) lds=50368
; @launch kernel=mlpb_kernel grid=(256,1,1) block=(512,1,1) lds=163840
.amdgcn_target "amdgcn-amd-amdhsa--gfx950"
.text
.globl f1_kernel
.type f1_kernel,@function
.globl conv2_kernel
.type conv2_kernel,@function
.globl mlpa_kernel
.type mlpa_kernel,@function
.globl mlpb_kernel
.type mlpb_kernel,@function
.p2align 8
f1_kernel:
    s_load_dwordx2 s[4:5], s[0:1], 104
    s_load_dwordx2 s[28:29], s[0:1], 96
    s_sub_u32 s3, s2, 760
    s_cmp_ge_u32 s3, 8
    s_cbranch_scc1 P_NOPF
    s_getpc_b64 s[6:7]
P_NOPF_PC:
    v_lshlrev_b32 v1, 6, v0
    global_load_dword v142, v1, s[6:7]
    v_add_u32 v1, 0x4000, v1
    v_min_u32 v1, TEXT_END-P_NOPF_PC-4, v1
    global_load_dword v143, v1, s[6:7]
P_NOPF:
    s_cmp_lt_u32 s2, 256
    s_cbranch_scc1 P_TR
    s_cmp_ge_u32 s2, 768
    s_cbranch_scc1 CONV_END
    s_load_dwordx4 s[8:11], s[0:1], 8
    s_load_dwordx4 s[12:15], s[0:1], 24
    s_load_dwordx2 s[16:17], s[0:1], 40
    s_load_dwordx2 s[6:7], s[0:1], 48
    s_load_dwordx4 s[48:51], s[0:1], 64
    s_load_dwordx2 s[52:53], s[0:1], 80
    s_sub_u32 s2, s2, 256
    s_mov_b32 s40, 0x3fb8aa3b
    s_mov_b32 s41, 0x32a57060
    s_mov_b32 s42, 0x3f317218
    v_lshrrev_b32 v65, 1, v0
    v_and_b32 v65, 0x60, v65
    v_and_or_b32 v65, v0, 31, v65
    s_lshl_b32 s37, s2, 8
    v_lshl_add_u32 v66, v65, 1, s37
    s_lshl_b32 s45, s2, 1
    v_mov_b32 v67, s45
    v_readfirstlane_b32 s33, v0
    s_nop 0
    s_lshr_b32 s33, s33, 6
    v_and_b32 v84, 15, v0
    v_bfe_u32 v85, v0, 4, 2
    v_lshrrev_b32 v87, 3, v84
    v_and_b32 v88, 7, v84
    v_lshl_add_u32 v87, v87, 7, v88
    v_cvt_f32_u32 v94, v87
    v_lshrrev_b32 v87, 2, v84
    v_lshlrev_b32 v88, 1, v87
    v_add_u32 v88, 0x100, v88
    v_lshlrev_b32 v89, 8, v87
    v_cmp_gt_u32 vcc, 2, v87
    s_nop 1
    v_cndmask_b32 v88, v89, v88, vcc
    v_bfe_u32 v89, v84, 1, 1
    v_lshl_add_u32 v88, v89, 7, v88
    v_and_b32 v89, 1, v84
    v_lshl_add_u32 v88, v89, 2, v88
    v_cvt_f32_u32 v95, v88
    v_lshlrev_b32 v87, 7, v84
    v_add_u32 v87, 0x400, v87
    v_cvt_f32_u32 v96, v87
    v_lshlrev_b32 v87, 3, v84
    v_cvt_f32_u32 v97, v87
    s_lshl_b32 s34, s33, 9
    v_lshl_add_u32 v98, v85, 6, s34
    v_lshrrev_b32 v87, 1, v85
    v_and_b32 v88, 1, v85
    v_lshlrev_b32 v88, 2, v88
    v_lshl_add_u32 v99, v87, 7, v88
    v_lshl_add_u32 v99, v84, 3, v99
    v_mov_b32 v100, 1
    v_mov_b32 v101, 2
    s_cmp_eq_u32 s33, 0
    s_cbranch_scc1 F_KA
    v_lshl_add_u32 v99, v85, 6, v84
    v_add_u32 v99, 0x200, v99
    v_mov_b32 v100, 16
    v_mov_b32 v101, 32
    s_cmp_lg_u32 s33, 1
    s_cbranch_scc1 F_KA
    v_lshl_add_u32 v87, v84, 2, v85
    v_add_u32 v87, 0x100, v87
    v_lshlrev_b32 v88, 6, v85
    v_lshl_add_u32 v88, v84, 1, v88
    v_add_u32 v88, 0x100, v88
    v_cmp_gt_u32 vcc, 2, v85
    s_nop 1
    v_cndmask_b32 v99, v88, v87, vcc
    v_cndmask_b32 v100, 1, 2, vcc
    v_cndmask_b32 v101, 32, 64, vcc
F_KA:
    v_add_u32 v102, v100, v101
    v_add_lshl_u32 v100, v100, v99, 1
    v_add_lshl_u32 v101, v101, v99, 1
    v_add_lshl_u32 v102, v102, v99, 1
    v_lshlrev_b32 v99, 1, v99
    v_and_b32 v103, 63, v0
    v_lshlrev_b32 v103, 4, v103
    s_waitcnt lgkmcnt(0)
    global_load_ushort v148, v66, s[8:9]
    s_and_b32 s26, s2, 31
    s_lshl_b32 s26, s26, 7
    s_add_u32 s26, s26, 262144
    v_mov_b32 v43, s26
    global_load_dword v42, v43, s[4:5] sc1
    global_load_ushort v149, v67, s[16:17]
    global_load_ushort v150, v66, s[10:11]
    global_load_ushort v151, v66, s[12:13]
    global_load_ushort v152, v66, s[14:15]
    v_mov_b32 v153, v65
    s_mov_b32 s30, 0
    s_mov_b32 s31, 0
    s_mov_b32 s32, 8650752
    s_mov_b32 s18, 28096
    v_readfirstlane_b32 s17, v0
    s_mov_b32 s43, 0x3b000000
    s_mov_b32 s44, 0x3727c5ac
    s_mov_b32 s45, 0x3727c5ac
    s_mov_b32 s46, 0x3b000000
    s_mov_b32 s47, 0x3b000000
    s_lshr_b32 s17, s17, 6
    s_mul_i32 s12, s2, 4352
    s_add_u32 s13, s12, s30
    s_lshl_b32 s14, s2, 8
    s_add_u32 s14, s14, s32
    s_mul_i32 s15, s2, 1536
    s_add_u32 s15, s15, 524288
    s_lshr_b32 s16, s2, 1
    s_lshl_b32 s16, s16, 2
    v_lshlrev_b32 v1, 4, v0
    v_and_b32 v3, 15, v0
    v_bfe_u32 v4, v0, 4, 2
    v_and_b32 v5, 63, v0
    v_lshlrev_b32 v6, 4, v5
    s_and_b32 s21, s2, 7
    v_bfe_u32 v2, v0, 1, 3
    v_xor_b32 v2, s21, v2
    v_lshlrev_b32 v2, 5, v2
    v_lshrrev_b32 v8, 4, v0
    v_lshl_add_u32 v2, v8, 17, v2
    v_and_b32 v8, 1, v0
    v_lshl_add_u32 v2, v8, 4, v2
    s_load_dword s20, s[6:7], s16
    s_mov_b32 s8, s4
    s_and_b32 s9, s5, 0xffff
    s_mov_b32 s10, 0x10000000
    s_mov_b32 s11, 0x20000
    v_mov_b32 v36, 0
    v_mov_b32 v37, 0
    v_mov_b32 v38, 0
    v_mov_b32 v39, 0
    v_lshlrev_b32 v40, 3, v0
    s_sub_u32 s19, s18, 34048
    v_add_u32 v48, -3, v40
    v_max_i32 v48, 0, v48
    v_cvt_f32_u32 v60, v48
    v_add_u32 v49, -2, v40
    v_max_i32 v49, 0, v49
    v_cvt_f32_u32 v61, v49
    v_add_u32 v50, -1, v40
    v_max_i32 v50, 0, v50
    v_cvt_f32_u32 v62, v50
    v_add_u32 v51, 0, v40
    v_cvt_f32_u32 v63, v51
    v_add_u32 v52, 1, v40
    v_cvt_f32_u32 v64, v52
    v_add_u32 v53, 2, v40
    v_cvt_f32_u32 v65, v53
    v_add_u32 v54, 3, v40
    v_cvt_f32_u32 v66, v54
    v_add_u32 v55, 4, v40
    v_cvt_f32_u32 v67, v55
    v_add_u32 v56, 5, v40
    v_cvt_f32_u32 v68, v56
    v_add_u32 v57, 6, v40
    v_cvt_f32_u32 v69, v57
    v_add_u32 v58, 7, v40
    v_cvt_f32_u32 v70, v58
    v_cvt_pk_bf16_f32 v72, v60, v61
    v_cvt_pk_bf16_f32 v73, v62, v63
    v_cvt_pk_bf16_f32 v74, v64, v65
    v_cvt_pk_bf16_f32 v75, v66, v67
    v_cvt_pk_bf16_f32 v76, v68, v69
    v_cvt_pk_bf16_f32 v77, v70, v70
    v_and_b32 v60, 0xffff, v72
    v_lshl_add_u32 v60, v60, 1, s19
    v_lshl_add_u32 v48, v48, 1, s18
    v_lshrrev_b32 v61, 16, v72
    v_lshl_add_u32 v61, v61, 1, s19
    v_lshl_add_u32 v49, v49, 1, s18
    v_and_b32 v62, 0xffff, v73
    v_lshl_add_u32 v62, v62, 1, s19
    v_lshl_add_u32 v50, v50, 1, s18
    v_lshrrev_b32 v63, 16, v73
    v_lshl_add_u32 v63, v63, 1, s19
    v_lshl_add_u32 v51, v51, 1, s18
    v_and_b32 v64, 0xffff, v74
    v_lshl_add_u32 v64, v64, 1, s19
    v_lshl_add_u32 v52, v52, 1, s18
    v_lshrrev_b32 v65, 16, v74
    v_lshl_add_u32 v65, v65, 1, s19
    v_lshl_add_u32 v53, v53, 1, s18
    v_and_b32 v66, 0xffff, v75
    v_lshl_add_u32 v66, v66, 1, s19
    v_lshl_add_u32 v54, v54, 1, s18
    v_lshrrev_b32 v67, 16, v75
    v_lshl_add_u32 v67, v67, 1, s19
    v_lshl_add_u32 v55, v55, 1, s18
    v_and_b32 v68, 0xffff, v76
    v_lshl_add_u32 v68, v68, 1, s19
    v_lshl_add_u32 v56, v56, 1, s18
    v_lshrrev_b32 v69, 16, v76
    v_lshl_add_u32 v69, v69, 1, s19
    v_lshl_add_u32 v57, v57, 1, s18
    v_and_b32 v70, 0xffff, v77
    v_lshl_add_u32 v70, v70, 1, s19
    v_lshl_add_u32 v58, v58, 1, s18
    v_cmp_gt_u32 s[24:25], 17, v0
    s_nop 1
    v_cndmask_b32 v48, v60, v48, s[24:25]
    v_cndmask_b32 v49, v61, v49, s[24:25]
    v_cndmask_b32 v50, v62, v50, s[24:25]
    v_cndmask_b32 v51, v63, v51, s[24:25]
    v_cndmask_b32 v52, v64, v52, s[24:25]
    v_cndmask_b32 v53, v65, v53, s[24:25]
    v_cndmask_b32 v54, v66, v54, s[24:25]
    v_cndmask_b32 v55, v67, v55, s[24:25]
    v_cndmask_b32 v56, v68, v56, s[24:25]
    v_cndmask_b32 v57, v69, v57, s[24:25]
    v_cndmask_b32 v58, v70, v58, s[24:25]
    s_and_b32 s21, s17, 1
    s_sub_u32 s22, 56, s21
    s_mul_i32 s21, s21, 4576
    v_min_u32 v9, s22, v5
    v_lshl_add_u32 v9, v9, 3, s21
    ds_write_b64 v9, v[36:37]
    v_and_b32 v9, 1, v3
    v_mul_u32_u24 v9, 4576, v9
    v_lshrrev_b32 v10, 1, v3
    v_lshlrev_b32 v11, 2, v10
    v_sub_u32 v11, v11, v4
    s_lshl_b32 s21, s17, 2
    s_sub_u32 s21, 15, s21
    v_add_u32 v11, s21, v11
    v_lshl_add_u32 v9, v11, 4, v9
    v_and_b32 v7, 3, v3
    v_mul_u32_u24 v7, 4160, v7
    v_lshrrev_b32 v8, 2, v3
    v_add_u32 v8, v8, v4
    v_lshl_add_u32 v7, v8, 4, v7
    s_lshl_b32 s21, s17, 6
    s_add_u32 s21, s21, 9152
    v_add_u32 v7, s21, v7
    v_xor_b32 v8, v4, v10
    v_and_b32 v8, 3, v8
    v_lshlrev_b32 v8, 1, v8
    v_lshl_add_u32 v8, v10, 3, v8
    v_and_b32 v11, 1, v3
    v_add_u32 v8, v8, v11
    s_lshl_b32 s21, s17, 11
    v_lshl_add_u32 v10, v8, 4, s21
    v_bfe_u32 v8, v0, 2, 3
    v_xor_b32 v11, v8, v0
    v_and_b32 v11, 3, v11
    v_lshlrev_b32 v11, 5, v11
    v_lshl_add_u32 v11, v8, 7, v11
    v_bfe_u32 v8, v0, 5, 1
    v_lshl_add_u32 v11, v8, 10, v11
    s_lshl_b32 s21, s17, 13
    s_add_u32 s21, s21, 25792
    s_cmp_eq_u32 s17, 3
    s_cselect_b32 s21, 9152, s21
    v_add_u32 v11, s21, v11
    v_and_b32 v61, 3, v0
    v_mov_b32 v62, 0
    v_lshrrev_b32 v60, 2, v0
    v_lshlrev_b32 v60, 15, v60
    v_lshl_add_u32 v60, v61, 4, v60
    s_lshl_b32 s13, s2, 6
    s_add_u32 s13, s13, 6291456
    s_waitcnt vmcnt(0)
    v_mov_b32 v68, v148
    v_mov_b32 v72, v149
    v_mov_b32 v69, v150
    v_mov_b32 v70, v151
    v_mov_b32 v71, v152
    v_mov_b32 v65, v153
    v_lshlrev_b32 v68, 16, v68
    v_lshlrev_b32 v72, 16, v72
    v_mul_f32 v80, s40, v72
    v_fma_f32 v81, s40, v72, -v80
    v_fma_f32 v81, s41, v72, v81
    v_exp_f32 v74, v80
    v_mul_f32 v81, s42, v81
    v_fma_f32 v74, v74, v81, v74
    v_mul_f32 v82, s40, v68
    v_fma_f32 v83, s40, v68, -v82
    v_fma_f32 v83, s41, v68, v83
    v_exp_f32 v75, v82
    v_mul_f32 v83, s42, v83
    v_fma_f32 v75, v75, v83, v75
    v_cvt_pk_bf16_f32 v74, v74, v75
    v_and_b32 v75, 0xffff0000, v74
    v_lshlrev_b32 v74, 16, v74
    v_mul_f32 v76, v75, v74
    v_mul_f32 v76, s40, v76
    v_sub_f32 v76, 0, v76
    v_lshlrev_b32 v69, 16, v69
    v_lshlrev_b32 v70, 16, v70
    v_lshlrev_b32 v71, 16, v71
    v_mul_f32 v77, v69, v74
    v_mul_f32 v77, 0.15915494, v77
    v_add_f32 v74, v74, v74
    v_mul_f32 v78, v70, v74
    v_mul_f32 v79, v71, v74
    v_lshlrev_b32 v73, 4, v65
    ds_write_b128 v73, v[76:79] offset:25792
    v_max3_f32 v80, |v78|, |v79|, 0
    s_nop 1
    v_max_f32_dpp v80, v80, v80 row_shr:1 row_mask:0xf bank_mask:0xf
    s_nop 1
    v_max_f32_dpp v80, v80, v80 row_shr:2 row_mask:0xf bank_mask:0xf
    s_nop 1
    v_max_f32_dpp v80, v80, v80 row_shr:4 row_mask:0xf bank_mask:0xf
    s_nop 1
    v_max_f32_dpp v80, v80, v80 row_shr:8 row_mask:0xf bank_mask:0xf
    s_nop 1
    v_max_f32_dpp v80, v80, v80 row_bcast:15 row_mask:0xa bank_mask:0xf
    s_nop 0
    v_readlane_b32 s35, v80, 31
    s_mov_b32 s34, 0
    s_nop 0
    v_mov_b32 v80, s35
    v_bfe_u32 v80, v80, 23, 8
    v_max_u32 v80, 14, v80
    v_sub_u32 v81, 0x8c, v80
    v_cvt_f32_i32 v93, v81
    v_mov_b32 v92, 0
    v_subrev_u32 v80, 13, v80
    v_lshlrev_b32 v91, 23, v80
F_KLOOP:
    ds_read_b128 v[116:119], v98 offset:25792
    ds_read_b128 v[120:123], v98 offset:25808
    ds_read_b128 v[124:127], v98 offset:25824
    ds_read_b128 v[128:131], v98 offset:25840
    v_add_u32 v98, 0x100, v98
    s_waitcnt lgkmcnt(3)
    v_pk_mul_f32 v[66:67], v[94:95], v[116:117] op_sel_hi:[1,0]
    v_pk_fma_f32 v[68:69], v[96:97], v[116:117], v[92:93] op_sel_hi:[1,0,1]
    v_pk_mul_f32 v[70:71], v[94:95], v[116:117] op_sel:[0,1] op_sel_hi:[1,1]
    v_pk_mul_f32 v[72:73], v[96:97], v[116:117] op_sel:[0,1] op_sel_hi:[1,1]
    v_exp_f32 v66, v66
    v_exp_f32 v67, v67
    v_exp_f32 v68, v68
    v_exp_f32 v69, v69
    v_fract_f32 v70, v70
    v_fract_f32 v71, v71
    v_fract_f32 v72, v72
    v_fract_f32 v73, v73
    v_cos_f32 v74, v70
    v_sin_f32 v75, v70
    v_cos_f32 v76, v71
    v_sin_f32 v77, v71
    v_cos_f32 v78, v72
    v_sin_f32 v79, v72
    v_cos_f32 v80, v73
    v_sin_f32 v81, v73
    v_pk_mul_f32 v[74:75], v[74:75], v[66:67] op_sel_hi:[1,0]
    v_pk_mul_f32 v[76:77], v[76:77], v[66:67] op_sel:[0,1] op_sel_hi:[1,1]
    v_pk_mul_f32 v[78:79], v[78:79], v[68:69] op_sel_hi:[1,0]
    v_pk_mul_f32 v[80:81], v[80:81], v[68:69] op_sel:[0,1] op_sel_hi:[1,1]
    v_cvt_pk_f16_f32 v132, v74, v75
    v_cvt_pk_f16_f32 v136, v76, v77
    v_cvt_pk_f16_f32 v140, v78, v79
    v_pk_mul_f32 v[82:83], v[80:81], v[118:119] op_sel_hi:[1,0]
    v_pk_fma_f32 v[82:83], v[80:81], v[118:119], v[82:83] op_sel:[1,1,0] op_sel_hi:[0,1,1] neg_lo:[1,0,0]
    v_cvt_pk_f16_f32 v144, v82, -v83
    s_waitcnt lgkmcnt(2)
    v_pk_mul_f32 v[66:67], v[94:95], v[120:121] op_sel_hi:[1,0]
    v_pk_fma_f32 v[68:69], v[96:97], v[120:121], v[92:93] op_sel_hi:[1,0,1]
    v_pk_mul_f32 v[70:71], v[94:95], v[120:121] op_sel:[0,1] op_sel_hi:[1,1]
    v_pk_mul_f32 v[72:73], v[96:97], v[120:121] op_sel:[0,1] op_sel_hi:[1,1]
    v_exp_f32 v66, v66
    v_exp_f32 v67, v67
    v_exp_f32 v68, v68
    v_exp_f32 v69, v69
    v_fract_f32 v70, v70
    v_fract_f32 v71, v71
    v_fract_f32 v72, v72
    v_fract_f32 v73, v73
    v_cos_f32 v74, v70
    v_sin_f32 v75, v70
    v_cos_f32 v76, v71
    v_sin_f32 v77, v71
    v_cos_f32 v78, v72
    v_sin_f32 v79, v72
    v_cos_f32 v80, v73
    v_sin_f32 v81, v73
    v_pk_mul_f32 v[74:75], v[74:75], v[66:67] op_sel_hi:[1,0]
    v_pk_mul_f32 v[76:77], v[76:77], v[66:67] op_sel:[0,1] op_sel_hi:[1,1]
    v_pk_mul_f32 v[78:79], v[78:79], v[68:69] op_sel_hi:[1,0]
    v_pk_mul_f32 v[80:81], v[80:81], v[68:69] op_sel:[0,1] op_sel_hi:[1,1]
    v_cvt_pk_f16_f32 v133, v74, v75
    v_cvt_pk_f16_f32 v137, v76, v77
    v_cvt_pk_f16_f32 v141, v78, v79
    v_pk_mul_f32 v[82:83], v[80:81], v[122:123] op_sel_hi:[1,0]
    v_pk_fma_f32 v[82:83], v[80:81], v[122:123], v[82:83] op_sel:[1,1,0] op_sel_hi:[0,1,1] neg_lo:[1,0,0]
    v_cvt_pk_f16_f32 v145, v82, -v83
    s_waitcnt lgkmcnt(1)
    v_pk_mul_f32 v[66:67], v[94:95], v[124:125] op_sel_hi:[1,0]
    v_pk_fma_f32 v[68:69], v[96:97], v[124:125], v[92:93] op_sel_hi:[1,0,1]
    v_pk_mul_f32 v[70:71], v[94:95], v[124:125] op_sel:[0,1] op_sel_hi:[1,1]
    v_pk_mul_f32 v[72:73], v[96:97], v[124:125] op_sel:[0,1] op_sel_hi:[1,1]
    v_exp_f32 v66, v66
    v_exp_f32 v67, v67
    v_exp_f32 v68, v68
    v_exp_f32 v69, v69
    v_fract_f32 v70, v70
    v_fract_f32 v71, v71
    v_fract_f32 v72, v72
    v_fract_f32 v73, v73
    v_cos_f32 v74, v70
    v_sin_f32 v75, v70
    v_cos_f32 v76, v71
    v_sin_f32 v77, v71
    v_cos_f32 v78, v72
    v_sin_f32 v79, v72
    v_cos_f32 v80, v73
    v_sin_f32 v81, v73
    v_pk_mul_f32 v[74:75], v[74:75], v[66:67] op_sel_hi:[1,0]
    v_pk_mul_f32 v[76:77], v[76:77], v[66:67] op_sel:[0,1] op_sel_hi:[1,1]
    v_pk_mul_f32 v[78:79], v[78:79], v[68:69] op_sel_hi:[1,0]
    v_pk_mul_f32 v[80:81], v[80:81], v[68:69] op_sel:[0,1] op_sel_hi:[1,1]
    v_cvt_pk_f16_f32 v134, v74, v75
    v_cvt_pk_f16_f32 v138, v76, v77
    v_cvt_pk_f16_f32 v142, v78, v79
    v_pk_mul_f32 v[82:83], v[80:81], v[126:127] op_sel_hi:[1,0]
    v_pk_fma_f32 v[82:83], v[80:81], v[126:127], v[82:83] op_sel:[1,1,0] op_sel_hi:[0,1,1] neg_lo:[1,0,0]
    v_cvt_pk_f16_f32 v146, v82, -v83
    s_waitcnt lgkmcnt(0)
    v_pk_mul_f32 v[66:67], v[94:95], v[128:129] op_sel_hi:[1,0]
    v_pk_fma_f32 v[68:69], v[96:97], v[128:129], v[92:93] op_sel_hi:[1,0,1]
    v_pk_mul_f32 v[70:71], v[94:95], v[128:129] op_sel:[0,1] op_sel_hi:[1,1]
    v_pk_mul_f32 v[72:73], v[96:97], v[128:129] op_sel:[0,1] op_sel_hi:[1,1]
    v_exp_f32 v66, v66
    v_exp_f32 v67, v67
    v_exp_f32 v68, v68
    v_exp_f32 v69, v69
    v_fract_f32 v70, v70
    v_fract_f32 v71, v71
    v_fract_f32 v72, v72
    v_fract_f32 v73, v73
    v_cos_f32 v74, v70
    v_sin_f32 v75, v70
    v_cos_f32 v76, v71
    v_sin_f32 v77, v71
    v_cos_f32 v78, v72
    v_sin_f32 v79, v72
    v_cos_f32 v80, v73
    v_sin_f32 v81, v73
    v_pk_mul_f32 v[74:75], v[74:75], v[66:67] op_sel_hi:[1,0]
    v_pk_mul_f32 v[76:77], v[76:77], v[66:67] op_sel:[0,1] op_sel_hi:[1,1]
    v_pk_mul_f32 v[78:79], v[78:79], v[68:69] op_sel_hi:[1,0]
    v_pk_mul_f32 v[80:81], v[80:81], v[68:69] op_sel:[0,1] op_sel_hi:[1,1]
    v_cvt_pk_f16_f32 v135, v74, v75
    v_cvt_pk_f16_f32 v139, v76, v77
    v_cvt_pk_f16_f32 v143, v78, v79
    v_pk_mul_f32 v[82:83], v[80:81], v[130:131] op_sel_hi:[1,0]
    v_pk_fma_f32 v[82:83], v[80:81], v[130:131], v[82:83] op_sel:[1,1,0] op_sel_hi:[0,1,1] neg_lo:[1,0,0]
    v_cvt_pk_f16_f32 v147, v82, -v83
    s_cmp_eq_u32 s34, 1
    s_cbranch_scc1 F_KL2
    v_mfma_f32_16x16x32_f16 v[104:107], v[132:135], v[144:147], 0
    v_mfma_f32_16x16x32_f16 v[108:111], v[136:139], v[144:147], 0
    v_mfma_f32_16x16x32_f16 v[112:115], v[140:143], v[144:147], 0
    s_mov_b32 s34, 1
    s_branch F_KLOOP
F_KL2:
    v_mfma_f32_16x16x32_f16 v[104:107], v[132:135], v[144:147], v[104:107]
    v_mfma_f32_16x16x32_f16 v[108:111], v[136:139], v[144:147], v[108:111]
    v_mfma_f32_16x16x32_f16 v[112:115], v[140:143], v[144:147], v[112:115]
    s_mul_i32 s34, s33, 3072
    v_add_u32 v66, s34, v103
    s_lshl_b32 s34, s33, 10
    v_add_u32 v67, s34, v103
    v_mov_b32 v90, v91
    s_nop 0
    v_pk_mul_f32 v[104:105], v[104:105], v[90:91]
    v_pk_mul_f32 v[106:107], v[106:107], v[90:91]
    v_pk_mul_f32 v[108:109], v[108:109], v[90:91]
    v_pk_mul_f32 v[110:111], v[110:111], v[90:91]
    v_pk_mul_f32 v[112:113], v[112:113], v[90:91]
    v_pk_mul_f32 v[114:115], v[114:115], v[90:91]
    ds_write_b128 v66, v[104:107] offset:29888
    ds_write_b128 v66, v[108:111] offset:30912
    ds_write_b128 v66, v[112:115] offset:31936
    s_waitcnt lgkmcnt(0)
    s_barrier
    s_cmp_eq_u32 s33, 3
    s_cbranch_scc1 F_KS
    ds_read_b128 v[104:107], v67 offset:29888
    ds_read_b128 v[108:111], v67 offset:32960
    ds_read_b128 v[112:115], v67 offset:36032
    ds_read_b128 v[68:71], v67 offset:39104
    s_waitcnt lgkmcnt(2)
    v_pk_add_f32 v[104:105], v[104:105], v[108:109]
    v_pk_add_f32 v[106:107], v[106:107], v[110:111]
    s_waitcnt lgkmcnt(0)
    v_pk_add_f32 v[112:113], v[112:113], v[68:69]
    v_pk_add_f32 v[114:115], v[114:115], v[70:71]
    v_pk_add_f32 v[104:105], v[104:105], v[112:113]
    v_pk_add_f32 v[106:107], v[106:107], v[114:115]
    v_cvt_pk_bf16_f32 v104, v104, v105
    v_cvt_pk_bf16_f32 v106, v106, v107
    ds_write_b16 v99, v104 offset:28096
    ds_write_b16_d16_hi v100, v104 offset:28096
    ds_write_b16 v101, v106 offset:28096
    ds_write_b16_d16_hi v102, v106 offset:28096
F_KS:
    s_waitcnt lgkmcnt(0)
    s_barrier
    ds_read_u16 v48, v48
    ds_read_u16 v49, v49
    ds_read_u16 v50, v50
    ds_read_u16 v51, v51
    ds_read_u16 v52, v52
    ds_read_u16 v53, v53
    ds_read_u16 v54, v54
    ds_read_u16 v55, v55
    ds_read_u16 v56, v56
    ds_read_u16 v57, v57
    ds_read_u16 v58, v58
    v_min_u32 v61, 0x5f0, v1
    ds_read_b128 v[80:83], v61 offset:28096
    v_bfe_u32 v62, v0, 2, 2
    v_mul_u32_u24 v62, 4160, v62
    v_and_b32 v63, 3, v0
    v_min_u32 v63, 2, v63
    v_lshl_add_u32 v62, v63, 4, v62
    ds_write_b128 v62, v[36:39] offset:9152
    v_cmp_eq_u32 vcc, 0, v0
    s_waitcnt lgkmcnt(0)
    s_nop 0
    v_cndmask_b32 v48, v48, v36, vcc
    v_cndmask_b32 v49, v49, v36, vcc
    v_cndmask_b32 v50, v50, v36, vcc
    v_lshl_or_b32 v64, v54, 16, v55
    v_lshl_or_b32 v65, v52, 16, v53
    v_lshl_or_b32 v66, v50, 16, v51
    v_lshl_or_b32 v67, v48, 16, v49
    ds_write_b128 v1, v[64:67] offset:9200
    v_lshl_or_b32 v68, v55, 16, v56
    v_lshl_or_b32 v69, v53, 16, v54
    v_lshl_or_b32 v70, v51, 16, v52
    v_lshl_or_b32 v71, v49, 16, v50
    ds_write_b128 v1, v[68:71] offset:13360
    v_lshl_or_b32 v72, v56, 16, v57
    v_lshl_or_b32 v73, v54, 16, v55
    v_lshl_or_b32 v74, v52, 16, v53
    v_lshl_or_b32 v75, v50, 16, v51
    ds_write_b128 v1, v[72:75] offset:17520
    v_lshl_or_b32 v76, v57, 16, v58
    v_lshl_or_b32 v77, v55, 16, v56
    v_lshl_or_b32 v78, v53, 16, v54
    v_lshl_or_b32 v79, v51, 16, v52
    ds_write_b128 v1, v[76:79] offset:21680
    buffer_store_dwordx4 v[80:83], v61, s[8:11], s15 offen
    v_mov_b32 v62, 0
    s_cmp_lg_u32 s17, 3
    s_cbranch_scc1 F1_GO
    s_mov_b32 s26, 0
F1_CHK:
    global_load_dword v59, v43, s[4:5] sc1
    s_waitcnt vmcnt(0)
    v_sub_u32 v59, v59, v42
    v_cmp_le_u32 vcc, 4, v59
    s_nop 0
    s_cmp_lg_u64 vcc, 0
    s_cbranch_scc1 F1_GO
    s_add_u32 s26, s26, 1
    s_cmp_ge_u32 s26, 262144
    s_cbranch_scc1 F1_GO
    s_sleep 2
    s_and_b32 s21, s26, 63
    s_cmp_lg_u32 s21, 0
    s_cbranch_scc1 F1_CHK
    global_load_dword v59, v62, s[28:29] offset:8 sc1
    s_waitcnt vmcnt(0)
    v_cmp_gt_u32 vcc, 4, v59
    s_nop 0
    s_cmp_lg_u64 vcc, 0
    s_cbranch_scc1 F1_CHK
F1_GO:
    s_waitcnt lgkmcnt(0)
    s_barrier
    buffer_load_dwordx4 v[16:19], v1, s[8:11], s31 offen sc1
    s_add_u32 s31, s31, 0x1000
    buffer_load_dwordx4 v[20:23], v1, s[8:11], s31 offen sc1
    s_add_u32 s31, s31, 0x1000
    buffer_load_dwordx4 v[24:27], v1, s[8:11], s31 offen sc1
    s_add_u32 s31, s31, 0x1000
    buffer_load_dwordx4 v[28:31], v1, s[8:11], s31 offen sc1
    buffer_load_dwordx4 v[12:15], v60, s[8:11], s13 offen sc1
    v_mov_b32 v144, 0
    v_mov_b32 v145, 0
    v_mov_b32 v146, 0
    v_mov_b32 v147, 0
    v_mov_b32 v148, 0
    v_mov_b32 v149, 0
    v_mov_b32 v150, 0
    v_mov_b32 v151, 0
    v_mov_b32 v152, 0
    v_mov_b32 v153, 0
    v_mov_b32 v154, 0
    v_mov_b32 v155, 0
    v_mov_b32 v156, 0
    v_mov_b32 v157, 0
    v_mov_b32 v158, 0
    v_mov_b32 v159, 0
    v_mov_b32 v160, 0
    v_mov_b32 v161, 0
    v_mov_b32 v162, 0
    v_mov_b32 v163, 0
    v_mov_b32 v164, 0
    v_mov_b32 v165, 0
    v_mov_b32 v166, 0
    s_mov_b32 s54, 2
    s_cmp_ge_u32 s2, 416
    s_cbranch_scc1 U_LDONE
    s_cmp_ge_u32 s2, 240
    s_cbranch_scc1 U_LD
    s_mov_b32 s54, 0
    s_lshr_b32 s21, s2, 4
    s_and_b32 s22, s2, 15
    s_mul_i32 s23, s22, 88064
    s_mul_i32 s27, s21, 192
    s_add_u32 s23, s23, s27
    s_mul_i32 s30, s21, 12
    s_mov_b32 s39, 0x15555556
    v_mov_b32 v91, 172
    v_add_u32 v84, 0, v0
    v_mul_hi_u32 v85, v84, s39
    v_mul_u32_u24 v86, 12, v85
    v_sub_u32 v86, v84, v86
    v_mul_u32_u24 v87, 2752, v85
    v_lshl_add_u32 v87, v86, 4, v87
    v_add_u32 v88, s23, v87
    v_mul_u32_u24 v87, 400, v85
    v_lshl_add_u32 v160, v86, 5, v87
    v_add_u32 v86, s30, v86
    v_cmp_gt_u32 s[24:25], v91, v86
    v_add_u32 v84, 256, v0
    v_mul_hi_u32 v85, v84, s39
    v_mul_u32_u24 v86, 12, v85
    v_sub_u32 v86, v84, v86
    v_mul_u32_u24 v87, 2752, v85
    v_lshl_add_u32 v87, v86, 4, v87
    v_add_u32 v89, s23, v87
    v_mul_u32_u24 v87, 400, v85
    v_lshl_add_u32 v161, v86, 5, v87
    v_add_u32 v86, s30, v86
    v_cmp_gt_u32 s[26:27], v91, v86
    s_mov_b64 exec, s[24:25]
    s_cbranch_execz U_W1
    global_load_dwordx4 v[144:147], v88, s[48:49]
    global_load_dwordx4 v[148:151], v88, s[50:51]
U_W1:
    s_mov_b64 exec, -1
    s_cmp_ge_u32 s33, 2
    s_cbranch_scc1 U_W2
    s_mov_b64 exec, s[26:27]
    s_cbranch_execz U_W2
    global_load_dwordx4 v[152:155], v89, s[48:49]
    global_load_dwordx4 v[156:159], v89, s[50:51]
U_W2:
    s_mov_b64 exec, -1
    v_add_u32 v160, 0, v160
    v_add_u32 v161, 0, v161
    v_lshrrev_b32 v86, 2, v3
    v_lshl_add_u32 v86, v4, 2, v86
    v_mul_u32_u24 v86, 400, v86
    v_and_b32 v87, 3, v3
    v_lshl_add_u32 v86, v87, 3, v86
    s_lshl_b32 s46, s33, 7
    s_mov_b32 s47, 32
    s_cmp_eq_u32 s33, 3
    s_cselect_b32 s46, 96, s46
    s_cselect_b32 s47, 128, s47
    s_add_u32 s46, s46, 0
    v_add_u32 v162, s46, v86
    v_add_u32 v163, s47, v162
    v_add_u32 v164, s47, v163
    s_lshl_b32 s55, s21, 2
    s_add_u32 s55, s55, s33
    s_lshl_b32 s55, s55, 4
    s_add_u32 s55, s55, s22
    s_mul_i32 s55, s55, 3072
    s_add_u32 s55, s55, 1572864
    v_lshl_add_u32 v165, v5, 4, s55
    s_branch U_LDONE
U_LD:
    s_mov_b32 s54, 1
    s_sub_u32 s56, s2, 240
    s_lshr_b32 s21, s56, 2
    s_and_b32 s22, s56, 3
    v_lshrrev_b32 v84, 4, v0
    s_lshl_b32 s23, s21, 15
    s_lshl_b32 s27, s22, 8
    s_add_u32 s23, s23, s27
    v_lshlrev_b32 v86, 10, v84
    v_lshl_add_u32 v86, v3, 4, v86
    v_add_u32 v86, s23, v86
    v_add_u32 v87, 0x4000, v86
    s_cmp_ge_u32 s21, 43
    s_cbranch_scc1 U_D1
    global_load_dwordx4 v[144:147], v86, s[52:53]
    global_load_dwordx4 v[148:151], v87, s[52:53]
U_D1:
    v_bfe_u32 v88, v84, 1, 2
    v_lshrrev_b32 v89, 3, v84
    v_and_b32 v90, 1, v84
    v_lshl_add_u32 v90, v89, 1, v90
    v_lshl_add_u32 v90, v88, 3, v90
    v_mul_u32_u24 v90, 272, v90
    v_lshl_add_u32 v90, v3, 4, v90
    v_add_u32 v160, 0, v90
    v_lshrrev_b32 v86, 2, v3
    v_lshl_add_u32 v86, v4, 3, v86
    v_mul_u32_u24 v86, 272, v86
    v_and_b32 v87, 3, v3
    v_lshl_add_u32 v86, v87, 3, v86
    s_lshl_b32 s46, s33, 6
    s_add_u32 s46, s46, 0
    v_add_u32 v162, s46, v86
    s_lshl_b32 s30, s22, 3
    s_lshl_b32 s39, s33, 1
    s_add_u32 s30, s30, s39
    s_mul_i32 s30, s30, 45056
    s_lshl_b32 s39, s21, 10
    s_add_u32 s30, s30, s39
    s_add_u32 s30, s30, 4718592
    v_lshl_add_u32 v165, v5, 4, s30
    v_add_u32 v166, 45056, v165
U_LDONE:
    s_waitcnt vmcnt(4)
    s_lshr_b32 s21, s17, 1
    s_or_b32 s21, s21, s54
    s_cmp_eq_u32 s21, 0
    s_cbranch_scc1 F_W3
    s_waitcnt vmcnt(2)
    s_cmp_lt_u32 s2, 412
    s_cbranch_scc1 F_W3
    s_waitcnt vmcnt(0)
F_W3:
    v_lshlrev_b32 v40, 16, v12
    v_and_b32 v41, 0xffff0000, v12
    v_sub_f32 v40, v40, v16
    v_sub_f32 v41, v41, v18
    v_cvt_pk_bf16_f32 v41, v40, v41
    v_lshlrev_b32 v40, 16, v41
    v_and_b32 v41, 0xffff0000, v41
    v_mul_f32 v40, v40, v17
    v_mul_f32 v41, v41, v19
    v_cvt_pk_bf16_f32 v32, v40, v41
    v_lshlrev_b32 v40, 16, v13
    v_and_b32 v41, 0xffff0000, v13
    v_sub_f32 v40, v40, v20
    v_sub_f32 v41, v41, v22
    v_cvt_pk_bf16_f32 v41, v40, v41
    v_lshlrev_b32 v40, 16, v41
    v_and_b32 v41, 0xffff0000, v41
    v_mul_f32 v40, v40, v21
    v_mul_f32 v41, v41, v23
    v_cvt_pk_bf16_f32 v33, v40, v41
    v_lshlrev_b32 v40, 16, v14
    v_and_b32 v41, 0xffff0000, v14
    v_sub_f32 v40, v40, v24
    v_sub_f32 v41, v41, v26
    v_cvt_pk_bf16_f32 v41, v40, v41
    v_lshlrev_b32 v40, 16, v41
    v_and_b32 v41, 0xffff0000, v41
    v_mul_f32 v40, v40, v25
    v_mul_f32 v41, v41, v27
    v_cvt_pk_bf16_f32 v34, v40, v41
    v_lshlrev_b32 v40, 16, v15
    v_and_b32 v41, 0xffff0000, v15
    v_sub_f32 v40, v40, v28
    v_sub_f32 v41, v41, v30
    v_cvt_pk_bf16_f32 v41, v40, v41
    v_lshlrev_b32 v40, 16, v41
    v_and_b32 v41, 0xffff0000, v41
    v_mul_f32 v40, v40, v29
    v_mul_f32 v41, v41, v31
    v_cvt_pk_bf16_f32 v35, v40, v41
    ds_write_b128 v1, v[32:35] offset:5024
    ds_write2_b64 v1, v[32:33], v[34:35] offset0:57 offset1:58
    s_branch CONV_PRE
F1_TAIL:
    s_barrier
    s_waitcnt vmcnt(1)
    s_cmp_eq_u32 s54, 2
    s_cbranch_scc1 U_SDONE
    s_cmp_eq_u32 s54, 1
    s_cbranch_scc1 U_SD
    ds_write2_b32 v160, v144, v145 offset0:0 offset1:2
    ds_write2_b32 v160, v146, v147 offset0:4 offset1:6
    ds_write2_b32 v160, v148, v149 offset0:1 offset1:3
    ds_write2_b32 v160, v150, v151 offset0:5 offset1:7
    s_cmp_ge_u32 s17, 2
    s_cbranch_scc1 U_SDONE
    ds_write2_b32 v161, v152, v153 offset0:0 offset1:2
    ds_write2_b32 v161, v154, v155 offset0:4 offset1:6
    ds_write2_b32 v161, v156, v157 offset0:1 offset1:3
    ds_write2_b32 v161, v158, v159 offset0:5 offset1:7
    s_branch U_SDONE
U_SD:
    ds_write_b128 v160, v[144:147]
    ds_write_b128 v160, v[148:151] offset:1088
U_SDONE:
    s_waitcnt lgkmcnt(0)
    s_barrier
    s_cmp_eq_u32 s54, 2
    s_cbranch_scc1 U_RDONE
    s_cmp_eq_u32 s54, 1
    s_cbranch_scc1 U_RD
    ds_read_b64_tr_b16 v[64:65], v162
    ds_read_b64_tr_b16 v[66:67], v162 offset:6400
    ds_read_b64_tr_b16 v[68:69], v163
    ds_read_b64_tr_b16 v[70:71], v163 offset:6400
    ds_read_b64_tr_b16 v[72:73], v164
    ds_read_b64_tr_b16 v[74:75], v164 offset:6400
    s_waitcnt lgkmcnt(0)
    global_store_dwordx4 v165, v[64:67], s[4:5] sc1
    global_store_dwordx4 v165, v[68:71], s[4:5] offset:1024 sc1
    global_store_dwordx4 v165, v[72:75], s[4:5] offset:2048 sc1
    s_branch U_RDONE
U_RD:
    ds_read_b64_tr_b16 v[64:65], v162
    ds_read_b64_tr_b16 v[66:67], v162 offset:1088
    ds_read_b64_tr_b16 v[68:69], v162 offset:32
    ds_read_b64_tr_b16 v[70:71], v162 offset:1120
    s_waitcnt lgkmcnt(0)
    global_store_dwordx4 v165, v[64:67], s[4:5] sc1
    global_store_dwordx4 v166, v[68:71], s[4:5] sc1
    s_branch U_RDONE
U_RDONE:
    s_endpgm

P_TR:
    s_load_dwordx2 s[8:9], s[0:1], 0
    s_load_dwordx4 s[16:19], s[0:1], 64
    s_load_dwordx2 s[20:21], s[0:1], 80
    s_sub_u32 s3, s2, 0
    s_lshr_b32 s10, s3, 3
    s_and_b32 s11, s3, 7
    v_lshrrev_b32 v1, 3, v0
    v_and_b32 v2, 7, v0
    s_lshl_b32 s12, s10, 16
    s_lshl_b32 s13, s11, 7
    s_add_u32 s12, s12, s13
    v_lshlrev_b32 v3, 10, v1
    v_lshl_add_u32 v3, v2, 4, v3
    v_add_u32 v3, s12, v3
    v_add_u32 v4, 0x8000, v3
    s_waitcnt lgkmcnt(0)
    global_load_dwordx4 v[8:11], v3, s[8:9]
    global_load_dwordx4 v[12:15], v4, s[8:9]
    v_lshrrev_b32 v41, 6, v0
    v_and_b32 v42, 63, v0
    s_lshl_b32 s14, s3, 13
    v_lshlrev_b32 v43, 11, v41
    v_lshl_add_u32 v43, v42, 4, v43
    v_add_u32 v43, s14, v43
    global_load_dwordx4 v[48:51], v43, s[8:9]
    global_load_dwordx4 v[52:55], v43, s[8:9] offset:1024
    s_setprio 0
    v_mul_u32_u24 v5, 144, v1
    v_lshl_add_u32 v5, v2, 4, v5
    v_and_b32 v6, 15, v0
    v_bfe_u32 v7, v0, 4, 2
    v_lshrrev_b32 v16, 6, v0
    v_lshrrev_b32 v17, 2, v6
    v_lshl_add_u32 v17, v7, 3, v17
    v_mul_u32_u24 v17, 144, v17
    v_and_b32 v18, 3, v6
    v_lshl_add_u32 v17, v18, 3, v17
    v_lshl_add_u32 v17, v16, 5, v17
    s_setprio 3
    s_lshl_b32 s12, s10, 16
    s_lshl_b32 s13, s11, 12
    s_add_u32 s12, s12, s13
    s_add_u32 s12, s12, 6291456
    v_lshl_add_u32 v19, v16, 4, v6
    v_lshlrev_b32 v19, 6, v19
    v_lshl_add_u32 v19, v7, 4, v19
    v_add_u32 v19, s12, v19
    v_add_u32 v44, 0x8000, v19
    s_waitcnt vmcnt(2)
    ds_write_b128 v5, v[8:11]
    ds_write_b128 v5, v[12:15] offset:4608
    s_waitcnt lgkmcnt(0)
    s_barrier
    ds_read_b64_tr_b16 v[8:9], v17
    ds_read_b64_tr_b16 v[10:11], v17 offset:576
    ds_read_b64_tr_b16 v[12:13], v17 offset:4608
    ds_read_b64_tr_b16 v[14:15], v17 offset:5184
    s_waitcnt lgkmcnt(0)
    global_store_dwordx4 v19, v[8:11], s[4:5] sc1
    global_store_dwordx4 v44, v[12:15], s[4:5] sc1
    v_mov_b32 v2, v42
    s_lshl_b32 s10, s3, 4
    v_lshlrev_b32 v4, 12, v41
    v_add_u32 v4, s10, v4
    v_add_u32 v5, 0, v4
    v_add_u32 v6, 16384, v4
    s_waitcnt vmcnt(2)
    v_lshlrev_b32 v16, 16, v48
    v_and_b32 v17, 0xffff0000, v48
    v_add_f32 v20, v16, v17
    v_mul_f32 v21, v16, v16
    v_fmac_f32 v21, v17, v17
    v_lshlrev_b32 v16, 16, v49
    v_and_b32 v17, 0xffff0000, v49
    v_add_f32 v20, v20, v16
    v_add_f32 v20, v20, v17
    v_fmac_f32 v21, v16, v16
    v_fmac_f32 v21, v17, v17
    v_lshlrev_b32 v16, 16, v50
    v_and_b32 v17, 0xffff0000, v50
    v_add_f32 v20, v20, v16
    v_add_f32 v20, v20, v17
    v_fmac_f32 v21, v16, v16
    v_fmac_f32 v21, v17, v17
    v_lshlrev_b32 v16, 16, v51
    v_and_b32 v17, 0xffff0000, v51
    v_add_f32 v20, v20, v16
    v_add_f32 v20, v20, v17
    v_fmac_f32 v21, v16, v16
    v_fmac_f32 v21, v17, v17
    v_lshlrev_b32 v16, 16, v52
    v_and_b32 v17, 0xffff0000, v52
    v_add_f32 v22, v16, v17
    v_mul_f32 v23, v16, v16
    v_fmac_f32 v23, v17, v17
    v_lshlrev_b32 v16, 16, v53
    v_and_b32 v17, 0xffff0000, v53
    v_add_f32 v22, v22, v16
    v_add_f32 v22, v22, v17
    v_fmac_f32 v23, v16, v16
    v_fmac_f32 v23, v17, v17
    v_lshlrev_b32 v16, 16, v54
    v_and_b32 v17, 0xffff0000, v54
    v_add_f32 v22, v22, v16
    v_add_f32 v22, v22, v17
    v_fmac_f32 v23, v16, v16
    v_fmac_f32 v23, v17, v17
    v_lshlrev_b32 v16, 16, v55
    v_and_b32 v17, 0xffff0000, v55
    v_add_f32 v22, v22, v16
    v_add_f32 v22, v22, v17
    v_fmac_f32 v23, v16, v16
    v_fmac_f32 v23, v17, v17
    v_add_f32_dpp v20, v20, v20 row_shr:1 row_mask:0xf bank_mask:0xf bound_ctrl:0
    v_add_f32_dpp v21, v21, v21 row_shr:1 row_mask:0xf bank_mask:0xf bound_ctrl:0
    v_add_f32_dpp v22, v22, v22 row_shr:1 row_mask:0xf bank_mask:0xf bound_ctrl:0
    v_add_f32_dpp v23, v23, v23 row_shr:1 row_mask:0xf bank_mask:0xf bound_ctrl:0
    v_add_f32_dpp v20, v20, v20 row_shr:2 row_mask:0xf bank_mask:0xf bound_ctrl:0
    v_add_f32_dpp v21, v21, v21 row_shr:2 row_mask:0xf bank_mask:0xf bound_ctrl:0
    v_add_f32_dpp v22, v22, v22 row_shr:2 row_mask:0xf bank_mask:0xf bound_ctrl:0
    v_add_f32_dpp v23, v23, v23 row_shr:2 row_mask:0xf bank_mask:0xf bound_ctrl:0
    v_add_f32_dpp v20, v20, v20 row_shr:4 row_mask:0xf bank_mask:0xf bound_ctrl:0
    v_add_f32_dpp v21, v21, v21 row_shr:4 row_mask:0xf bank_mask:0xf bound_ctrl:0
    v_add_f32_dpp v22, v22, v22 row_shr:4 row_mask:0xf bank_mask:0xf bound_ctrl:0
    v_add_f32_dpp v23, v23, v23 row_shr:4 row_mask:0xf bank_mask:0xf bound_ctrl:0
    v_add_f32_dpp v20, v20, v20 row_shr:8 row_mask:0xf bank_mask:0xf bound_ctrl:0
    v_add_f32_dpp v21, v21, v21 row_shr:8 row_mask:0xf bank_mask:0xf bound_ctrl:0
    v_add_f32_dpp v22, v22, v22 row_shr:8 row_mask:0xf bank_mask:0xf bound_ctrl:0
    v_add_f32_dpp v23, v23, v23 row_shr:8 row_mask:0xf bank_mask:0xf bound_ctrl:0
    v_add_f32_dpp v20, v20, v20 row_bcast:15 row_mask:0xa bank_mask:0xf
    v_add_f32_dpp v21, v21, v21 row_bcast:15 row_mask:0xa bank_mask:0xf
    v_add_f32_dpp v22, v22, v22 row_bcast:15 row_mask:0xa bank_mask:0xf
    v_add_f32_dpp v23, v23, v23 row_bcast:15 row_mask:0xa bank_mask:0xf
    v_add_f32_dpp v20, v20, v20 row_bcast:31 row_mask:0xc bank_mask:0xf
    v_add_f32_dpp v21, v21, v21 row_bcast:31 row_mask:0xc bank_mask:0xf
    v_add_f32_dpp v22, v22, v22 row_bcast:31 row_mask:0xc bank_mask:0xf
    v_add_f32_dpp v23, v23, v23 row_bcast:31 row_mask:0xc bank_mask:0xf
    s_mov_b32 s43, 0x3b000000
    s_mov_b32 s44, 0x3727c5ac
    v_mul_f32 v20, s43, v20
    v_mul_f32 v21, s43, v21
    v_fma_f32 v21, -v20, v20, v21
    v_max_f32 v21, 0, v21
    v_cvt_pk_bf16_f32 v21, v20, v21
    v_lshlrev_b32 v20, 16, v21
    v_and_b32 v21, 0xffff0000, v21
    v_add_f32 v21, s44, v21
    v_mul_f32 v22, s43, v22
    v_mul_f32 v23, s43, v23
    v_fma_f32 v23, -v22, v22, v23
    v_max_f32 v23, 0, v23
    v_cvt_pk_bf16_f32 v23, v22, v23
    v_lshlrev_b32 v22, 16, v23
    v_and_b32 v23, 0xffff0000, v23
    v_add_f32 v23, s44, v23
    v_cvt_pk_bf16_f32 v40, v21, v23
    v_lshlrev_b32 v21, 16, v40
    v_and_b32 v23, 0xffff0000, v40
    v_sqrt_f32 v21, v21
    v_sqrt_f32 v23, v23
    s_nop 0
    v_cvt_pk_bf16_f32 v40, v21, v23
    v_lshlrev_b32 v21, 16, v40
    v_and_b32 v23, 0xffff0000, v40
    v_rcp_f32 v21, v21
    v_rcp_f32 v23, v23
    v_mov_b32 v24, 0
    v_mov_b32 v25, 0
    v_mov_b32 v26, 0
    v_mov_b32 v27, 0
    s_lshl_b32 s10, s3, 9
    s_add_u32 s10, s10, 65536
    v_and_b32 v7, 31, v0
    v_lshl_add_u32 v7, v7, 4, s10
    global_store_dwordx4 v7, v[24:27], s[4:5]
    v_cmp_eq_u32 vcc, 63, v2
    s_nop 0
    s_and_saveexec_b64 s[22:23], vcc
    global_store_dwordx4 v5, v[20:23], s[4:5] sc1
    global_store_dwordx4 v6, v[24:27], s[4:5]
    s_mov_b64 exec, -1
    s_and_b32 s10, s2, 3
    s_lshl_b32 s10, s10, 6
    v_mov_b32 v8, s10
    v_mov_b32 v9, 1
    v_cmp_eq_u32 vcc, 0, v0
    s_waitcnt vmcnt(0)
    s_barrier
    v_readfirstlane_b32 s10, v0
    s_nop 0
    s_cmp_lg_u32 s10, 0
    s_cbranch_scc1 P_TEND
    s_mov_b64 exec, 1
    global_atomic_add v10, v8, v9, s[28:29] sc0 sc1
    s_waitcnt vmcnt(0)
    v_readfirstlane_b32 s10, v10
    s_nop 0
    s_cmp_lg_u32 s10, 63
    s_cbranch_scc1 P_TEND
    v_mov_b32 v8, 8
    global_atomic_add v8, v9, s[28:29] sc1
    s_mov_b64 exec, -1
    v_lshlrev_b32 v8, 7, v0
    v_add_u32 v8, 262144, v8
    s_mov_b64 exec, 4294967295
    global_atomic_add v8, v9, s[4:5] sc1
P_TEND:
    s_mov_b64 exec, -1
    s_setprio 0
    s_cmp_lt_u32 s2, 90
    s_cbranch_scc1 P_C
    s_endpgm
P_C:
    s_load_dwordx4 s[8:11], s[0:1], 64
    s_sub_u32 s3, s2, 0
    s_and_b32 s12, s3, 1
    s_lshr_b32 s13, s3, 1
    v_lshrrev_b32 v1, 2, v0
    v_and_b32 v2, 3, v0
    s_lshl_b32 s14, s13, 6
    v_mul_u32_u24 v4, 2752, v1
    v_lshl_add_u32 v4, v2, 4, v4
    v_add_u32 v4, s14, v4
    v_mov_b32 v8, 0
    v_mov_b32 v9, 0
    v_mov_b32 v10, 0
    v_mov_b32 v11, 0
    v_mov_b32 v12, 0
    v_mov_b32 v13, 0
    v_mov_b32 v14, 0
    v_mov_b32 v15, 0
    s_waitcnt lgkmcnt(0)
    s_cmp_eq_u32 s12, 1
    s_cselect_b32 s8, s10, s8
    s_cselect_b32 s9, s11, s9
    s_cmp_ge_u32 s13, 43
    s_cbranch_scc1 P_C2
    global_load_dwordx4 v[16:19], v4, s[8:9]
    v_add_u32 v4, 176128, v4
    global_load_dwordx4 v[20:23], v4, s[8:9]
    v_add_u32 v4, 176128, v4
    global_load_dwordx4 v[24:27], v4, s[8:9]
    v_add_u32 v4, 176128, v4
    global_load_dwordx4 v[28:31], v4, s[8:9]
    v_add_u32 v4, 176128, v4
    global_load_dwordx4 v[32:35], v4, s[8:9]
    v_add_u32 v4, 176128, v4
    global_load_dwordx4 v[36:39], v4, s[8:9]
    v_add_u32 v4, 176128, v4
    global_load_dwordx4 v[40:43], v4, s[8:9]
    v_add_u32 v4, 176128, v4
    global_load_dwordx4 v[44:47], v4, s[8:9]
    s_setprio 0
    s_waitcnt vmcnt(7)
    v_lshlrev_b32 v6, 16, v16
    v_and_b32 v7, 0xffff0000, v16
    v_pk_add_f32 v[8:9], v[8:9], v[6:7]
    v_lshlrev_b32 v6, 16, v17
    v_and_b32 v7, 0xffff0000, v17
    v_pk_add_f32 v[10:11], v[10:11], v[6:7]
    v_lshlrev_b32 v6, 16, v18
    v_and_b32 v7, 0xffff0000, v18
    v_pk_add_f32 v[12:13], v[12:13], v[6:7]
    v_lshlrev_b32 v6, 16, v19
    v_and_b32 v7, 0xffff0000, v19
    v_pk_add_f32 v[14:15], v[14:15], v[6:7]
    s_waitcnt vmcnt(6)
    v_lshlrev_b32 v6, 16, v20
    v_and_b32 v7, 0xffff0000, v20
    v_pk_add_f32 v[8:9], v[8:9], v[6:7]
    v_lshlrev_b32 v6, 16, v21
    v_and_b32 v7, 0xffff0000, v21
    v_pk_add_f32 v[10:11], v[10:11], v[6:7]
    v_lshlrev_b32 v6, 16, v22
    v_and_b32 v7, 0xffff0000, v22
    v_pk_add_f32 v[12:13], v[12:13], v[6:7]
    v_lshlrev_b32 v6, 16, v23
    v_and_b32 v7, 0xffff0000, v23
    v_pk_add_f32 v[14:15], v[14:15], v[6:7]
    s_waitcnt vmcnt(5)
    v_lshlrev_b32 v6, 16, v24
    v_and_b32 v7, 0xffff0000, v24
    v_pk_add_f32 v[8:9], v[8:9], v[6:7]
    v_lshlrev_b32 v6, 16, v25
    v_and_b32 v7, 0xffff0000, v25
    v_pk_add_f32 v[10:11], v[10:11], v[6:7]
    v_lshlrev_b32 v6, 16, v26
    v_and_b32 v7, 0xffff0000, v26
    v_pk_add_f32 v[12:13], v[12:13], v[6:7]
    v_lshlrev_b32 v6, 16, v27
    v_and_b32 v7, 0xffff0000, v27
    v_pk_add_f32 v[14:15], v[14:15], v[6:7]
    s_waitcnt vmcnt(4)
    v_lshlrev_b32 v6, 16, v28
    v_and_b32 v7, 0xffff0000, v28
    v_pk_add_f32 v[8:9], v[8:9], v[6:7]
    v_lshlrev_b32 v6, 16, v29
    v_and_b32 v7, 0xffff0000, v29
    v_pk_add_f32 v[10:11], v[10:11], v[6:7]
    v_lshlrev_b32 v6, 16, v30
    v_and_b32 v7, 0xffff0000, v30
    v_pk_add_f32 v[12:13], v[12:13], v[6:7]
    v_lshlrev_b32 v6, 16, v31
    v_and_b32 v7, 0xffff0000, v31
    v_pk_add_f32 v[14:15], v[14:15], v[6:7]
    s_waitcnt vmcnt(3)
    v_lshlrev_b32 v6, 16, v32
    v_and_b32 v7, 0xffff0000, v32
    v_pk_add_f32 v[8:9], v[8:9], v[6:7]
    v_lshlrev_b32 v6, 16, v33
    v_and_b32 v7, 0xffff0000, v33
    v_pk_add_f32 v[10:11], v[10:11], v[6:7]
    v_lshlrev_b32 v6, 16, v34
    v_and_b32 v7, 0xffff0000, v34
    v_pk_add_f32 v[12:13], v[12:13], v[6:7]
    v_lshlrev_b32 v6, 16, v35
    v_and_b32 v7, 0xffff0000, v35
    v_pk_add_f32 v[14:15], v[14:15], v[6:7]
    s_waitcnt vmcnt(2)
    v_lshlrev_b32 v6, 16, v36
    v_and_b32 v7, 0xffff0000, v36
    v_pk_add_f32 v[8:9], v[8:9], v[6:7]
    v_lshlrev_b32 v6, 16, v37
    v_and_b32 v7, 0xffff0000, v37
    v_pk_add_f32 v[10:11], v[10:11], v[6:7]
    v_lshlrev_b32 v6, 16, v38
    v_and_b32 v7, 0xffff0000, v38
    v_pk_add_f32 v[12:13], v[12:13], v[6:7]
    v_lshlrev_b32 v6, 16, v39
    v_and_b32 v7, 0xffff0000, v39
    v_pk_add_f32 v[14:15], v[14:15], v[6:7]
    s_waitcnt vmcnt(1)
    v_lshlrev_b32 v6, 16, v40
    v_and_b32 v7, 0xffff0000, v40
    v_pk_add_f32 v[8:9], v[8:9], v[6:7]
    v_lshlrev_b32 v6, 16, v41
    v_and_b32 v7, 0xffff0000, v41
    v_pk_add_f32 v[10:11], v[10:11], v[6:7]
    v_lshlrev_b32 v6, 16, v42
    v_and_b32 v7, 0xffff0000, v42
    v_pk_add_f32 v[12:13], v[12:13], v[6:7]
    v_lshlrev_b32 v6, 16, v43
    v_and_b32 v7, 0xffff0000, v43
    v_pk_add_f32 v[14:15], v[14:15], v[6:7]
    s_waitcnt vmcnt(0)
    v_lshlrev_b32 v6, 16, v44
    v_and_b32 v7, 0xffff0000, v44
    v_pk_add_f32 v[8:9], v[8:9], v[6:7]
    v_lshlrev_b32 v6, 16, v45
    v_and_b32 v7, 0xffff0000, v45
    v_pk_add_f32 v[10:11], v[10:11], v[6:7]
    v_lshlrev_b32 v6, 16, v46
    v_and_b32 v7, 0xffff0000, v46
    v_pk_add_f32 v[12:13], v[12:13], v[6:7]
    v_lshlrev_b32 v6, 16, v47
    v_and_b32 v7, 0xffff0000, v47
    v_pk_add_f32 v[14:15], v[14:15], v[6:7]
    v_add_f32_dpp v8, v8, v8 row_shr:4 row_mask:0xf bank_mask:0xf bound_ctrl:0
    v_add_f32_dpp v9, v9, v9 row_shr:4 row_mask:0xf bank_mask:0xf bound_ctrl:0
    v_add_f32_dpp v10, v10, v10 row_shr:4 row_mask:0xf bank_mask:0xf bound_ctrl:0
    v_add_f32_dpp v11, v11, v11 row_shr:4 row_mask:0xf bank_mask:0xf bound_ctrl:0
    v_add_f32_dpp v12, v12, v12 row_shr:4 row_mask:0xf bank_mask:0xf bound_ctrl:0
    v_add_f32_dpp v13, v13, v13 row_shr:4 row_mask:0xf bank_mask:0xf bound_ctrl:0
    v_add_f32_dpp v14, v14, v14 row_shr:4 row_mask:0xf bank_mask:0xf bound_ctrl:0
    v_add_f32_dpp v15, v15, v15 row_shr:4 row_mask:0xf bank_mask:0xf bound_ctrl:0
    v_add_f32_dpp v8, v8, v8 row_shr:8 row_mask:0xf bank_mask:0xf bound_ctrl:0
    v_add_f32_dpp v9, v9, v9 row_shr:8 row_mask:0xf bank_mask:0xf bound_ctrl:0
    v_add_f32_dpp v10, v10, v10 row_shr:8 row_mask:0xf bank_mask:0xf bound_ctrl:0
    v_add_f32_dpp v11, v11, v11 row_shr:8 row_mask:0xf bank_mask:0xf bound_ctrl:0
    v_add_f32_dpp v12, v12, v12 row_shr:8 row_mask:0xf bank_mask:0xf bound_ctrl:0
    v_add_f32_dpp v13, v13, v13 row_shr:8 row_mask:0xf bank_mask:0xf bound_ctrl:0
    v_add_f32_dpp v14, v14, v14 row_shr:8 row_mask:0xf bank_mask:0xf bound_ctrl:0
    v_add_f32_dpp v15, v15, v15 row_shr:8 row_mask:0xf bank_mask:0xf bound_ctrl:0
P_C2:
    v_lshrrev_b32 v6, 4, v0
    v_lshlrev_b32 v6, 7, v6
    v_lshl_add_u32 v6, v2, 5, v6
    v_and_b32 v7, 12, v0
    v_cmp_eq_u32 vcc, 12, v7
    s_nop 0
    s_and_saveexec_b64 s[46:47], vcc
    ds_write_b128 v6, v[8:11]
    ds_write_b128 v6, v[12:15] offset:16
    s_mov_b64 exec, s[46:47]
    s_waitcnt lgkmcnt(0)
    s_barrier
    v_cmp_gt_u32 vcc, 32, v0
    s_nop 0
    s_and_saveexec_b64 s[46:47], vcc
    s_cbranch_execz P_C3
    v_lshlrev_b32 v6, 2, v0
    ds_read_b32 v16, v6 offset:0
    ds_read_b32 v17, v6 offset:128
    ds_read_b32 v18, v6 offset:256
    ds_read_b32 v19, v6 offset:384
    ds_read_b32 v20, v6 offset:512
    ds_read_b32 v21, v6 offset:640
    ds_read_b32 v22, v6 offset:768
    ds_read_b32 v23, v6 offset:896
    ds_read_b32 v24, v6 offset:1024
    ds_read_b32 v25, v6 offset:1152
    ds_read_b32 v26, v6 offset:1280
    ds_read_b32 v27, v6 offset:1408
    ds_read_b32 v28, v6 offset:1536
    ds_read_b32 v29, v6 offset:1664
    ds_read_b32 v30, v6 offset:1792
    ds_read_b32 v31, v6 offset:1920
    s_mul_i32 s14, s13, 0x5556
    s_lshr_b32 s14, s14, 16
    s_mul_i32 s15, s14, 3
    s_sub_u32 s15, s13, s15
    s_mul_i32 s16, s15, 3
    s_add_u32 s17, s15, 9
    v_lshrrev_b32 v5, 3, v0
    v_add_u32 v7, s16, v5
    v_mov_b32 v8, s17
    v_cmp_eq_u32 vcc, 3, v5
    s_nop 1
    v_cndmask_b32 v7, v7, v8, vcc
    s_mul_i32 s14, s14, 12
    v_add_u32 v7, s14, v7
    v_lshlrev_b32 v7, 4, v7
    v_bfe_u32 v8, v0, 1, 2
    v_lshl_add_u32 v7, v8, 2, v7
    v_and_b32 v8, 1, v0
    v_add_u32 v7, v7, v8
    s_lshl_b32 s14, s12, 1
    v_add_u32 v7, s14, v7
    v_lshlrev_b32 v7, 2, v7
    v_add_u32 v7, 32768, v7
    s_waitcnt lgkmcnt(0)
    v_add_f32 v16, v16, v24
    v_add_f32 v17, v17, v25
    v_add_f32 v18, v18, v26
    v_add_f32 v19, v19, v27
    v_add_f32 v20, v20, v28
    v_add_f32 v21, v21, v29
    v_add_f32 v22, v22, v30
    v_add_f32 v23, v23, v31
    v_add_f32 v16, v16, v20
    v_add_f32 v17, v17, v21
    v_add_f32 v18, v18, v22
    v_add_f32 v19, v19, v23
    v_add_f32 v16, v16, v18
    v_add_f32 v17, v17, v19
    v_add_f32 v16, v16, v17
    global_store_dword v7, v16, s[4:5]
P_C3:
    s_endpgm

.p2align 8
conv2_kernel:
    s_mov_b32 s34, 1
    s_mov_b32 s30, 16777216
    s_mov_b32 s31, 16384
    s_mov_b32 s32, 19136512
    s_mov_b32 s33, 21233664
CONV_BODY:
    s_mov_b32 s54, 2
    s_cmp_ge_u32 s2, 512
    s_cbranch_scc1 CONV_END
    s_load_dwordx2 s[4:5], s[0:1], 104
    s_load_dwordx2 s[6:7], s[0:1], 48
    v_readfirstlane_b32 s17, v0
    s_mov_b32 s43, 0x3b000000
    s_mov_b32 s44, 0x3727c5ac
    s_mov_b32 s45, 0x3727c5ac
    s_mov_b32 s46, 0x3b000000
    s_mov_b32 s47, 0x3b000000
    s_lshr_b32 s17, s17, 6
    s_mul_i32 s12, s2, 4352
    s_add_u32 s13, s12, s30
    s_lshl_b32 s14, s2, 8
    s_add_u32 s14, s14, s32
    s_mul_i32 s15, s2, 1536
    s_add_u32 s15, s15, 524288
    s_lshr_b32 s16, s2, 1
    s_lshl_b32 s16, s16, 2
    v_lshlrev_b32 v1, 4, v0
    v_and_b32 v3, 15, v0
    v_bfe_u32 v4, v0, 4, 2
    v_and_b32 v5, 63, v0
    v_lshlrev_b32 v6, 4, v5
    s_and_b32 s21, s2, 7
    v_bfe_u32 v2, v0, 1, 3
    v_xor_b32 v2, s21, v2
    v_lshlrev_b32 v2, 5, v2
    v_lshrrev_b32 v8, 4, v0
    v_lshl_add_u32 v2, v8, 17, v2
    v_and_b32 v8, 1, v0
    v_lshl_add_u32 v2, v8, 4, v2
    s_lshl_b32 s18, s17, 11
    s_add_u32 s18, s18, 25792
    v_mov_b32 v36, 0
    v_mov_b32 v37, 0
    v_mov_b32 v38, 0
    v_mov_b32 v39, 0
    v_bfe_u32 v9, v0, 2, 2
    v_mul_u32_u24 v9, 4160, v9
    v_and_b32 v10, 3, v0
    v_min_u32 v10, 2, v10
    v_lshl_add_u32 v9, v10, 4, v9
    ds_write_b128 v9, v[36:39] offset:9152
    v_lshlrev_b32 v40, 3, v0
    s_sub_u32 s19, s18, 34048
    v_add_u32 v48, -3, v40
    v_max_i32 v48, 0, v48
    v_cvt_f32_u32 v60, v48
    v_add_u32 v49, -2, v40
    v_max_i32 v49, 0, v49
    v_cvt_f32_u32 v61, v49
    v_add_u32 v50, -1, v40
    v_max_i32 v50, 0, v50
    v_cvt_f32_u32 v62, v50
    v_add_u32 v51, 0, v40
    v_cvt_f32_u32 v63, v51
    v_add_u32 v52, 1, v40
    v_cvt_f32_u32 v64, v52
    v_add_u32 v53, 2, v40
    v_cvt_f32_u32 v65, v53
    v_add_u32 v54, 3, v40
    v_cvt_f32_u32 v66, v54
    v_add_u32 v55, 4, v40
    v_cvt_f32_u32 v67, v55
    v_add_u32 v56, 5, v40
    v_cvt_f32_u32 v68, v56
    v_add_u32 v57, 6, v40
    v_cvt_f32_u32 v69, v57
    v_add_u32 v58, 7, v40
    v_cvt_f32_u32 v70, v58
    v_cvt_pk_bf16_f32 v72, v60, v61
    v_cvt_pk_bf16_f32 v73, v62, v63
    v_cvt_pk_bf16_f32 v74, v64, v65
    v_cvt_pk_bf16_f32 v75, v66, v67
    v_cvt_pk_bf16_f32 v76, v68, v69
    v_cvt_pk_bf16_f32 v77, v70, v70
    v_and_b32 v60, 0xffff, v72
    v_lshl_add_u32 v60, v60, 1, s19
    v_lshl_add_u32 v48, v48, 1, s18
    v_lshrrev_b32 v61, 16, v72
    v_lshl_add_u32 v61, v61, 1, s19
    v_lshl_add_u32 v49, v49, 1, s18
    v_and_b32 v62, 0xffff, v73
    v_lshl_add_u32 v62, v62, 1, s19
    v_lshl_add_u32 v50, v50, 1, s18
    v_lshrrev_b32 v63, 16, v73
    v_lshl_add_u32 v63, v63, 1, s19
    v_lshl_add_u32 v51, v51, 1, s18
    v_and_b32 v64, 0xffff, v74
    v_lshl_add_u32 v64, v64, 1, s19
    v_lshl_add_u32 v52, v52, 1, s18
    v_lshrrev_b32 v65, 16, v74
    v_lshl_add_u32 v65, v65, 1, s19
    v_lshl_add_u32 v53, v53, 1, s18
    v_and_b32 v66, 0xffff, v75
    v_lshl_add_u32 v66, v66, 1, s19
    v_lshl_add_u32 v54, v54, 1, s18
    v_lshrrev_b32 v67, 16, v75
    v_lshl_add_u32 v67, v67, 1, s19
    v_lshl_add_u32 v55, v55, 1, s18
    v_and_b32 v68, 0xffff, v76
    v_lshl_add_u32 v68, v68, 1, s19
    v_lshl_add_u32 v56, v56, 1, s18
    v_lshrrev_b32 v69, 16, v76
    v_lshl_add_u32 v69, v69, 1, s19
    v_lshl_add_u32 v57, v57, 1, s18
    v_and_b32 v70, 0xffff, v77
    v_lshl_add_u32 v70, v70, 1, s19
    v_lshl_add_u32 v58, v58, 1, s18
    v_cmp_gt_u32 s[24:25], 17, v0
    s_nop 1
    v_cndmask_b32 v48, v60, v48, s[24:25]
    v_cndmask_b32 v49, v61, v49, s[24:25]
    v_cndmask_b32 v50, v62, v50, s[24:25]
    v_cndmask_b32 v51, v63, v51, s[24:25]
    v_cndmask_b32 v52, v64, v52, s[24:25]
    v_cndmask_b32 v53, v65, v53, s[24:25]
    v_cndmask_b32 v54, v66, v54, s[24:25]
    v_cndmask_b32 v55, v67, v55, s[24:25]
    v_cndmask_b32 v56, v68, v56, s[24:25]
    v_cndmask_b32 v57, v69, v57, s[24:25]
    v_cndmask_b32 v58, v70, v58, s[24:25]
    s_and_b32 s21, s17, 1
    s_sub_u32 s22, 56, s21
    s_mul_i32 s21, s21, 4576
    v_min_u32 v9, s22, v5
    v_lshl_add_u32 v9, v9, 3, s21
    ds_write_b64 v9, v[36:37]
    v_and_b32 v9, 1, v3
    v_mul_u32_u24 v9, 4576, v9
    v_lshrrev_b32 v10, 1, v3
    v_lshlrev_b32 v11, 2, v10
    v_sub_u32 v11, v11, v4
    s_lshl_b32 s21, s17, 2
    s_sub_u32 s21, 15, s21
    v_add_u32 v11, s21, v11
    v_lshl_add_u32 v9, v11, 4, v9
    v_and_b32 v7, 3, v3
    v_mul_u32_u24 v7, 4160, v7
    v_lshrrev_b32 v8, 2, v3
    v_add_u32 v8, v8, v4
    v_lshl_add_u32 v7, v8, 4, v7
    s_lshl_b32 s21, s17, 6
    s_add_u32 s21, s21, 9152
    v_add_u32 v7, s21, v7
    v_xor_b32 v8, v4, v10
    v_and_b32 v8, 3, v8
    v_lshlrev_b32 v8, 1, v8
    v_lshl_add_u32 v8, v10, 3, v8
    v_and_b32 v11, 1, v3
    v_add_u32 v8, v8, v11
    s_lshl_b32 s21, s17, 11
    v_lshl_add_u32 v10, v8, 4, s21
    v_bfe_u32 v8, v0, 2, 3
    v_xor_b32 v11, v8, v0
    v_and_b32 v11, 3, v11
    v_lshlrev_b32 v11, 5, v11
    v_lshl_add_u32 v11, v8, 7, v11
    v_bfe_u32 v8, v0, 5, 1
    v_lshl_add_u32 v11, v8, 10, v11
    s_lshl_b32 s21, s17, 13
    s_add_u32 s21, s21, 25792
    s_cmp_eq_u32 s17, 3
    s_cselect_b32 s21, 9152, s21
    v_add_u32 v11, s21, v11
    s_waitcnt lgkmcnt(0)
    s_load_dword s20, s[6:7], s16
    s_mov_b32 s8, s4
    s_and_b32 s9, s5, 0xffff
    s_mov_b32 s10, 0x10000000
    s_mov_b32 s11, 0x20000
    s_mov_b32 m0, s18
    s_nop 0
    buffer_load_dwordx4 v6, s[8:11], s15 offen lds
    buffer_load_dwordx4 v6, s[8:11], s15 offen offset:1024 lds
    buffer_load_dwordx4 v[16:19], v1, s[8:11], s31 offen
    s_add_u32 s31, s31, 0x1000
    buffer_load_dwordx4 v[20:23], v1, s[8:11], s31 offen
    s_add_u32 s31, s31, 0x1000
    buffer_load_dwordx4 v[24:27], v1, s[8:11], s31 offen
    s_add_u32 s31, s31, 0x1000
    buffer_load_dwordx4 v[28:31], v1, s[8:11], s31 offen
    buffer_load_dwordx4 v[12:15], v1, s[8:11], s13 offen
    s_waitcnt vmcnt(5)
    ds_read_u16 v48, v48
    ds_read_u16 v49, v49
    ds_read_u16 v50, v50
    ds_read_u16 v51, v51
    ds_read_u16 v52, v52
    ds_read_u16 v53, v53
    ds_read_u16 v54, v54
    ds_read_u16 v55, v55
    ds_read_u16 v56, v56
    ds_read_u16 v57, v57
    ds_read_u16 v58, v58
    v_cmp_eq_u32 vcc, 0, v0
    s_waitcnt lgkmcnt(0)
    s_nop 0
    v_cndmask_b32 v48, v48, v36, vcc
    v_cndmask_b32 v49, v49, v36, vcc
    v_cndmask_b32 v50, v50, v36, vcc
    v_lshl_or_b32 v64, v54, 16, v55
    v_lshl_or_b32 v65, v52, 16, v53
    v_lshl_or_b32 v66, v50, 16, v51
    v_lshl_or_b32 v67, v48, 16, v49
    ds_write_b128 v1, v[64:67] offset:9200
    v_lshl_or_b32 v68, v55, 16, v56
    v_lshl_or_b32 v69, v53, 16, v54
    v_lshl_or_b32 v70, v51, 16, v52
    v_lshl_or_b32 v71, v49, 16, v50
    ds_write_b128 v1, v[68:71] offset:13360
    v_lshl_or_b32 v72, v56, 16, v57
    v_lshl_or_b32 v73, v54, 16, v55
    v_lshl_or_b32 v74, v52, 16, v53
    v_lshl_or_b32 v75, v50, 16, v51
    ds_write_b128 v1, v[72:75] offset:17520
    v_lshl_or_b32 v76, v57, 16, v58
    v_lshl_or_b32 v77, v55, 16, v56
    v_lshl_or_b32 v78, v53, 16, v54
    v_lshl_or_b32 v79, v51, 16, v52
    ds_write_b128 v1, v[76:79] offset:21680
    s_waitcnt vmcnt(1)
    v_mul_f32 v16, s43, v16
    v_mul_f32 v17, s43, v17
    v_fma_f32 v17, -v16, v16, v17
    v_max_f32 v17, 0, v17
    v_cvt_pk_bf16_f32 v17, v16, v17
    v_lshlrev_b32 v16, 16, v17
    v_and_b32 v17, 0xffff0000, v17
    v_add_f32 v17, s44, v17
    v_mul_f32 v18, s43, v18
    v_mul_f32 v19, s43, v19
    v_fma_f32 v19, -v18, v18, v19
    v_max_f32 v19, 0, v19
    v_cvt_pk_bf16_f32 v19, v18, v19
    v_lshlrev_b32 v18, 16, v19
    v_and_b32 v19, 0xffff0000, v19
    v_add_f32 v19, s44, v19
    v_cvt_pk_bf16_f32 v40, v17, v19
    v_lshlrev_b32 v17, 16, v40
    v_and_b32 v19, 0xffff0000, v40
    v_sqrt_f32 v17, v17
    v_sqrt_f32 v19, v19
    s_nop 0
    v_cvt_pk_bf16_f32 v40, v17, v19
    v_lshlrev_b32 v17, 16, v40
    v_and_b32 v19, 0xffff0000, v40
    v_rcp_f32 v17, v17
    v_rcp_f32 v19, v19
    v_mul_f32 v20, s43, v20
    v_mul_f32 v21, s43, v21
    v_fma_f32 v21, -v20, v20, v21
    v_max_f32 v21, 0, v21
    v_cvt_pk_bf16_f32 v21, v20, v21
    v_lshlrev_b32 v20, 16, v21
    v_and_b32 v21, 0xffff0000, v21
    v_add_f32 v21, s44, v21
    v_mul_f32 v22, s43, v22
    v_mul_f32 v23, s43, v23
    v_fma_f32 v23, -v22, v22, v23
    v_max_f32 v23, 0, v23
    v_cvt_pk_bf16_f32 v23, v22, v23
    v_lshlrev_b32 v22, 16, v23
    v_and_b32 v23, 0xffff0000, v23
    v_add_f32 v23, s44, v23
    v_cvt_pk_bf16_f32 v40, v21, v23
    v_lshlrev_b32 v21, 16, v40
    v_and_b32 v23, 0xffff0000, v40
    v_sqrt_f32 v21, v21
    v_sqrt_f32 v23, v23
    s_nop 0
    v_cvt_pk_bf16_f32 v40, v21, v23
    v_lshlrev_b32 v21, 16, v40
    v_and_b32 v23, 0xffff0000, v40
    v_rcp_f32 v21, v21
    v_rcp_f32 v23, v23
    v_mul_f32 v24, s43, v24
    v_mul_f32 v25, s43, v25
    v_fma_f32 v25, -v24, v24, v25
    v_max_f32 v25, 0, v25
    v_cvt_pk_bf16_f32 v25, v24, v25
    v_lshlrev_b32 v24, 16, v25
    v_and_b32 v25, 0xffff0000, v25
    v_add_f32 v25, s44, v25
    v_mul_f32 v26, s43, v26
    v_mul_f32 v27, s43, v27
    v_fma_f32 v27, -v26, v26, v27
    v_max_f32 v27, 0, v27
    v_cvt_pk_bf16_f32 v27, v26, v27
    v_lshlrev_b32 v26, 16, v27
    v_and_b32 v27, 0xffff0000, v27
    v_add_f32 v27, s44, v27
    v_cvt_pk_bf16_f32 v40, v25, v27
    v_lshlrev_b32 v25, 16, v40
    v_and_b32 v27, 0xffff0000, v40
    v_sqrt_f32 v25, v25
    v_sqrt_f32 v27, v27
    s_nop 0
    v_cvt_pk_bf16_f32 v40, v25, v27
    v_lshlrev_b32 v25, 16, v40
    v_and_b32 v27, 0xffff0000, v40
    v_rcp_f32 v25, v25
    v_rcp_f32 v27, v27
    v_mul_f32 v28, s43, v28
    v_mul_f32 v29, s43, v29
    v_fma_f32 v29, -v28, v28, v29
    v_max_f32 v29, 0, v29
    v_cvt_pk_bf16_f32 v29, v28, v29
    v_lshlrev_b32 v28, 16, v29
    v_and_b32 v29, 0xffff0000, v29
    v_add_f32 v29, s44, v29
    v_mul_f32 v30, s43, v30
    v_mul_f32 v31, s43, v31
    v_fma_f32 v31, -v30, v30, v31
    v_max_f32 v31, 0, v31
    v_cvt_pk_bf16_f32 v31, v30, v31
    v_lshlrev_b32 v30, 16, v31
    v_and_b32 v31, 0xffff0000, v31
    v_add_f32 v31, s44, v31
    v_cvt_pk_bf16_f32 v40, v29, v31
    v_lshlrev_b32 v29, 16, v40
    v_and_b32 v31, 0xffff0000, v40
    v_sqrt_f32 v29, v29
    v_sqrt_f32 v31, v31
    s_nop 0
    v_cvt_pk_bf16_f32 v40, v29, v31
    v_lshlrev_b32 v29, 16, v40
    v_and_b32 v31, 0xffff0000, v40
    v_rcp_f32 v29, v29
    v_rcp_f32 v31, v31
    s_waitcnt vmcnt(0)
    v_lshlrev_b32 v40, 16, v12
    v_and_b32 v41, 0xffff0000, v12
    v_sub_f32 v40, v40, v16
    v_sub_f32 v41, v41, v18
    v_cvt_pk_bf16_f32 v41, v40, v41
    v_lshlrev_b32 v40, 16, v41
    v_and_b32 v41, 0xffff0000, v41
    v_mul_f32 v40, v40, v17
    v_mul_f32 v41, v41, v19
    v_cvt_pk_bf16_f32 v32, v40, v41
    v_lshlrev_b32 v40, 16, v13
    v_and_b32 v41, 0xffff0000, v13
    v_sub_f32 v40, v40, v20
    v_sub_f32 v41, v41, v22
    v_cvt_pk_bf16_f32 v41, v40, v41
    v_lshlrev_b32 v40, 16, v41
    v_and_b32 v41, 0xffff0000, v41
    v_mul_f32 v40, v40, v21
    v_mul_f32 v41, v41, v23
    v_cvt_pk_bf16_f32 v33, v40, v41
    v_lshlrev_b32 v40, 16, v14
    v_and_b32 v41, 0xffff0000, v14
    v_sub_f32 v40, v40, v24
    v_sub_f32 v41, v41, v26
    v_cvt_pk_bf16_f32 v41, v40, v41
    v_lshlrev_b32 v40, 16, v41
    v_and_b32 v41, 0xffff0000, v41
    v_mul_f32 v40, v40, v25
    v_mul_f32 v41, v41, v27
    v_cvt_pk_bf16_f32 v34, v40, v41
    v_lshlrev_b32 v40, 16, v15
    v_and_b32 v41, 0xffff0000, v15
    v_sub_f32 v40, v40, v28
    v_sub_f32 v41, v41, v30
    v_cvt_pk_bf16_f32 v41, v40, v41
    v_lshlrev_b32 v40, 16, v41
    v_and_b32 v41, 0xffff0000, v41
    v_mul_f32 v40, v40, v29
    v_mul_f32 v41, v41, v31
    v_cvt_pk_bf16_f32 v35, v40, v41
    ds_write_b128 v1, v[32:35] offset:5024
    ds_write2_b64 v1, v[32:33], v[34:35] offset0:57 offset1:58
    s_lshr_b32 s21, s2, 3
    s_lshl_b32 s21, s21, 2
    s_add_u32 s21, s21, s17
    s_mul_i32 s22, s21, 6144
    s_and_b32 s23, s2, 1
    s_mul_i32 s23, s23, 1572864
    s_add_u32 s22, s22, s23
    s_add_u32 s22, s22, 1572864
    v_lshlrev_b32 v38, 7, v5
    s_cmp_eq_u32 s34, 0
    s_cbranch_scc1 CONV_NOW
    buffer_load_dword v150, v38, s[8:11], s22 offen
CONV_NOW:
CONV_PRE:
    s_cmp_ge_u32 s2, 8
    s_cbranch_scc1 CONV_NOPF
    s_getpc_b64 s[22:23]
CONV_PFPC:
    v_lshlrev_b32 v38, 6, v0
    v_min_u32 v38, TEXT_END-CONV_PFPC-4, v38
    global_load_dword v39, v38, s[22:23]
CONV_NOPF:
    s_waitcnt lgkmcnt(0)
    s_barrier
CONV_MAIN2:
    ds_read_b128 v[16:19], v9 offset:0
    ds_read_b128 v[52:55], v7 offset:256
    ds_read_b128 v[60:63], v7 offset:768
    ds_read_b128 v[68:71], v7 offset:1280
    ds_read_b128 v[76:79], v7 offset:1792
    ds_read_b128 v[84:87], v7 offset:2304
    ds_read_b128 v[92:95], v7 offset:2816
    ds_read_b128 v[100:103], v7 offset:3328
    ds_read_b128 v[108:111], v7 offset:3840
    ds_read_b128 v[20:23], v9 offset:256
    ds_read_b128 v[48:51], v7 offset:0
    ds_read_b128 v[56:59], v7 offset:512
    s_waitcnt lgkmcnt(10)
    v_mfma_f32_16x16x32_bf16 v[112:115], v[52:55], v[16:19], 0
    ds_read_b128 v[64:67], v7 offset:1024
    s_waitcnt lgkmcnt(10)
    v_mfma_f32_16x16x32_bf16 v[116:119], v[60:63], v[16:19], 0
    ds_read_b128 v[72:75], v7 offset:1536
    s_waitcnt lgkmcnt(10)
    v_mfma_f32_16x16x32_bf16 v[120:123], v[68:71], v[16:19], 0
    ds_read_b128 v[80:83], v7 offset:2048
    s_waitcnt lgkmcnt(10)
    v_mfma_f32_16x16x32_bf16 v[124:127], v[76:79], v[16:19], 0
    ds_read_b128 v[88:91], v7 offset:2560
    s_waitcnt lgkmcnt(10)
    v_mfma_f32_16x16x32_bf16 v[128:131], v[84:87], v[16:19], 0
    ds_read_b128 v[96:99], v7 offset:3072
    s_waitcnt lgkmcnt(10)
    v_mfma_f32_16x16x32_bf16 v[132:135], v[92:95], v[16:19], 0
    ds_read_b128 v[104:107], v7 offset:3584
    s_waitcnt lgkmcnt(10)
    v_mfma_f32_16x16x32_bf16 v[136:139], v[100:103], v[16:19], 0
    ds_read_b128 v[24:27], v9 offset:512
    s_waitcnt lgkmcnt(10)
    v_mfma_f32_16x16x32_bf16 v[140:143], v[108:111], v[16:19], 0
    ds_read_b128 v[28:31], v9 offset:768
    ds_read_b128 v[16:19], v9 offset:1024
    s_waitcnt lgkmcnt(10)
    v_mfma_f32_16x16x32_bf16 v[112:115], v[48:51], v[20:23], v[112:115]
    s_waitcnt lgkmcnt(9)
    v_mfma_f32_16x16x32_bf16 v[116:119], v[56:59], v[20:23], v[116:119]
    s_waitcnt lgkmcnt(8)
    v_mfma_f32_16x16x32_bf16 v[120:123], v[64:67], v[20:23], v[120:123]
    s_waitcnt lgkmcnt(7)
    v_mfma_f32_16x16x32_bf16 v[124:127], v[72:75], v[20:23], v[124:127]
    s_waitcnt lgkmcnt(6)
    v_mfma_f32_16x16x32_bf16 v[128:131], v[80:83], v[20:23], v[128:131]
    s_waitcnt lgkmcnt(5)
    v_mfma_f32_16x16x32_bf16 v[132:135], v[88:91], v[20:23], v[132:135]
    s_waitcnt lgkmcnt(4)
    v_mfma_f32_16x16x32_bf16 v[136:139], v[96:99], v[20:23], v[136:139]
    s_waitcnt lgkmcnt(3)
    v_mfma_f32_16x16x32_bf16 v[140:143], v[104:107], v[20:23], v[140:143]
    ds_read_b128 v[20:23], v9 offset:1280
    s_waitcnt lgkmcnt(3)
    v_mfma_f32_16x16x32_bf16 v[116:119], v[52:55], v[24:27], v[116:119]
    v_mfma_f32_16x16x32_bf16 v[120:123], v[60:63], v[24:27], v[120:123]
    v_mfma_f32_16x16x32_bf16 v[124:127], v[68:71], v[24:27], v[124:127]
    v_mfma_f32_16x16x32_bf16 v[128:131], v[76:79], v[24:27], v[128:131]
    v_mfma_f32_16x16x32_bf16 v[132:135], v[84:87], v[24:27], v[132:135]
    v_mfma_f32_16x16x32_bf16 v[136:139], v[92:95], v[24:27], v[136:139]
    v_mfma_f32_16x16x32_bf16 v[140:143], v[100:103], v[24:27], v[140:143]
    ds_read_b128 v[24:27], v9 offset:1536
    s_waitcnt lgkmcnt(3)
    v_mfma_f32_16x16x32_bf16 v[116:119], v[48:51], v[28:31], v[116:119]
    v_mfma_f32_16x16x32_bf16 v[120:123], v[56:59], v[28:31], v[120:123]
    v_mfma_f32_16x16x32_bf16 v[124:127], v[64:67], v[28:31], v[124:127]
    v_mfma_f32_16x16x32_bf16 v[128:131], v[72:75], v[28:31], v[128:131]
    v_mfma_f32_16x16x32_bf16 v[132:135], v[80:83], v[28:31], v[132:135]
    v_mfma_f32_16x16x32_bf16 v[136:139], v[88:91], v[28:31], v[136:139]
    v_mfma_f32_16x16x32_bf16 v[140:143], v[96:99], v[28:31], v[140:143]
    ds_read_b128 v[28:31], v9 offset:1792
    ds_write_b128 v10, v[112:115] offset:25792
    s_waitcnt lgkmcnt(4)
    v_mfma_f32_16x16x32_bf16 v[120:123], v[52:55], v[16:19], v[120:123]
    v_mfma_f32_16x16x32_bf16 v[124:127], v[60:63], v[16:19], v[124:127]
    v_mfma_f32_16x16x32_bf16 v[128:131], v[68:71], v[16:19], v[128:131]
    v_mfma_f32_16x16x32_bf16 v[132:135], v[76:79], v[16:19], v[132:135]
    v_mfma_f32_16x16x32_bf16 v[136:139], v[84:87], v[16:19], v[136:139]
    v_mfma_f32_16x16x32_bf16 v[140:143], v[92:95], v[16:19], v[140:143]
    ds_read_b128 v[16:19], v9 offset:2048
    s_waitcnt lgkmcnt(4)
    v_mfma_f32_16x16x32_bf16 v[120:123], v[48:51], v[20:23], v[120:123]
    v_mfma_f32_16x16x32_bf16 v[124:127], v[56:59], v[20:23], v[124:127]
    v_mfma_f32_16x16x32_bf16 v[128:131], v[64:67], v[20:23], v[128:131]
    v_mfma_f32_16x16x32_bf16 v[132:135], v[72:75], v[20:23], v[132:135]
    v_mfma_f32_16x16x32_bf16 v[136:139], v[80:83], v[20:23], v[136:139]
    v_mfma_f32_16x16x32_bf16 v[140:143], v[88:91], v[20:23], v[140:143]
    ds_read_b128 v[20:23], v9 offset:2304
    ds_write_b128 v10, v[116:119] offset:26816
    s_waitcnt lgkmcnt(5)
    v_mfma_f32_16x16x32_bf16 v[124:127], v[52:55], v[24:27], v[124:127]
    v_mfma_f32_16x16x32_bf16 v[128:131], v[60:63], v[24:27], v[128:131]
    v_mfma_f32_16x16x32_bf16 v[132:135], v[68:71], v[24:27], v[132:135]
    v_mfma_f32_16x16x32_bf16 v[136:139], v[76:79], v[24:27], v[136:139]
    v_mfma_f32_16x16x32_bf16 v[140:143], v[84:87], v[24:27], v[140:143]
    ds_read_b128 v[24:27], v9 offset:2560
    s_barrier
    s_waitcnt lgkmcnt(5)
    v_mfma_f32_16x16x32_bf16 v[124:127], v[48:51], v[28:31], v[124:127]
    v_mfma_f32_16x16x32_bf16 v[128:131], v[56:59], v[28:31], v[128:131]
    v_mfma_f32_16x16x32_bf16 v[132:135], v[64:67], v[28:31], v[132:135]
    v_mfma_f32_16x16x32_bf16 v[136:139], v[72:75], v[28:31], v[136:139]
    v_mfma_f32_16x16x32_bf16 v[140:143], v[80:83], v[28:31], v[140:143]
    ds_read_b128 v[28:31], v9 offset:2816
    ds_write_b128 v10, v[120:123] offset:33984
    s_waitcnt lgkmcnt(5)
    v_mfma_f32_16x16x32_bf16 v[128:131], v[52:55], v[16:19], v[128:131]
    v_mfma_f32_16x16x32_bf16 v[132:135], v[60:63], v[16:19], v[132:135]
    v_mfma_f32_16x16x32_bf16 v[136:139], v[68:71], v[16:19], v[136:139]
    v_mfma_f32_16x16x32_bf16 v[140:143], v[76:79], v[16:19], v[140:143]
    ds_read_b128 v[16:19], v9 offset:3072
    s_waitcnt lgkmcnt(5)
    v_mfma_f32_16x16x32_bf16 v[128:131], v[48:51], v[20:23], v[128:131]
    v_mfma_f32_16x16x32_bf16 v[132:135], v[56:59], v[20:23], v[132:135]
    v_mfma_f32_16x16x32_bf16 v[136:139], v[64:67], v[20:23], v[136:139]
    v_mfma_f32_16x16x32_bf16 v[140:143], v[72:75], v[20:23], v[140:143]
    ds_read_b128 v[20:23], v9 offset:3328
    ds_write_b128 v10, v[124:127] offset:35008
    s_waitcnt lgkmcnt(5)
    v_mfma_f32_16x16x32_bf16 v[132:135], v[52:55], v[24:27], v[132:135]
    v_mfma_f32_16x16x32_bf16 v[136:139], v[60:63], v[24:27], v[136:139]
    v_mfma_f32_16x16x32_bf16 v[140:143], v[68:71], v[24:27], v[140:143]
    ds_read_b128 v[24:27], v9 offset:3584
    s_waitcnt lgkmcnt(5)
    v_mfma_f32_16x16x32_bf16 v[132:135], v[48:51], v[28:31], v[132:135]
    v_mfma_f32_16x16x32_bf16 v[136:139], v[56:59], v[28:31], v[136:139]
    v_mfma_f32_16x16x32_bf16 v[140:143], v[64:67], v[28:31], v[140:143]
    ds_read_b128 v[28:31], v9 offset:3840
    ds_write_b128 v10, v[128:131] offset:42176
    s_waitcnt lgkmcnt(5)
    v_mfma_f32_16x16x32_bf16 v[136:139], v[52:55], v[16:19], v[136:139]
    v_mfma_f32_16x16x32_bf16 v[140:143], v[60:63], v[16:19], v[140:143]
    s_waitcnt lgkmcnt(4)
    v_mfma_f32_16x16x32_bf16 v[136:139], v[48:51], v[20:23], v[136:139]
    v_mfma_f32_16x16x32_bf16 v[140:143], v[56:59], v[20:23], v[140:143]
    ds_write_b128 v10, v[132:135] offset:43200
    s_waitcnt lgkmcnt(3)
    v_mfma_f32_16x16x32_bf16 v[140:143], v[52:55], v[24:27], v[140:143]
    s_waitcnt lgkmcnt(2)
    v_mfma_f32_16x16x32_bf16 v[140:143], v[48:51], v[28:31], v[140:143]
    s_nop 1
    ds_write_b128 v10, v[136:139] offset:9152
    s_and_b32 s21, s20, 0xffff0000
    s_lshl_b32 s20, s20, 16
    s_bitcmp1_b32 s2, 0
    s_cselect_b32 s20, s21, s20
    v_lshlrev_b32 v40, 16, v32
    v_and_b32 v41, 0xffff0000, v32
    v_mul_f32 v40, s20, v40
    v_mul_f32 v41, s20, v41
    v_cvt_pk_bf16_f32 v41, v40, v41
    ds_write_b128 v10, v[140:143] offset:10176
    v_lshlrev_b32 v48, 16, v41
    v_and_b32 v49, 0xffff0000, v41
    v_lshlrev_b32 v56, 16, v12
    v_and_b32 v57, 0xffff0000, v12
    v_lshlrev_b32 v40, 16, v33
    v_and_b32 v41, 0xffff0000, v33
    v_mul_f32 v40, s20, v40
    v_mul_f32 v41, s20, v41
    v_cvt_pk_bf16_f32 v41, v40, v41
    v_lshlrev_b32 v50, 16, v41
    v_and_b32 v51, 0xffff0000, v41
    v_lshlrev_b32 v58, 16, v13
    v_and_b32 v59, 0xffff0000, v13
    v_lshlrev_b32 v40, 16, v34
    v_and_b32 v41, 0xffff0000, v34
    v_mul_f32 v40, s20, v40
    v_mul_f32 v41, s20, v41
    v_cvt_pk_bf16_f32 v41, v40, v41
    v_lshlrev_b32 v52, 16, v41
    v_and_b32 v53, 0xffff0000, v41
    v_lshlrev_b32 v60, 16, v14
    v_and_b32 v61, 0xffff0000, v14
    v_lshlrev_b32 v40, 16, v35
    v_and_b32 v41, 0xffff0000, v35
    v_mul_f32 v40, s20, v40
    v_mul_f32 v41, s20, v41
    v_cvt_pk_bf16_f32 v41, v40, v41
    v_lshlrev_b32 v54, 16, v41
    v_and_b32 v55, 0xffff0000, v41
    v_lshlrev_b32 v62, 16, v15
    v_and_b32 v63, 0xffff0000, v15
    s_waitcnt lgkmcnt(0)
    s_barrier
    ds_read_b128 v[112:115], v11 offset:0
    ds_read_b128 v[116:119], v11 offset:16
    ds_read_b128 v[120:123], v11 offset:2048
    ds_read_b128 v[124:127], v11 offset:2064
    ds_read_b128 v[128:131], v11 offset:4096
    ds_read_b128 v[132:135], v11 offset:4112
    ds_read_b128 v[136:139], v11 offset:6144
    ds_read_b128 v[140:143], v11 offset:6160
    s_waitcnt lgkmcnt(4)
    v_add_f32 v112, v112, v120
    v_add_f32 v113, v113, v121
    v_add_f32 v114, v114, v122
    v_add_f32 v115, v115, v123
    v_add_f32 v116, v116, v124
    v_add_f32 v117, v117, v125
    v_add_f32 v118, v118, v126
    v_add_f32 v119, v119, v127
    s_waitcnt lgkmcnt(0)
    v_add_f32 v128, v128, v136
    v_add_f32 v129, v129, v137
    v_add_f32 v130, v130, v138
    v_add_f32 v131, v131, v139
    v_add_f32 v132, v132, v140
    v_add_f32 v133, v133, v141
    v_add_f32 v134, v134, v142
    v_add_f32 v135, v135, v143
    v_add_f32 v112, v112, v128
    v_add_f32 v113, v113, v129
    v_add_f32 v114, v114, v130
    v_add_f32 v115, v115, v131
    v_add_f32 v116, v116, v132
    v_add_f32 v117, v117, v133
    v_add_f32 v118, v118, v134
    v_add_f32 v119, v119, v135
    v_cvt_pk_bf16_f32 v113, v112, v113
    v_lshlrev_b32 v112, 16, v113
    v_and_b32 v113, 0xffff0000, v113
    v_add_f32 v112, v112, v48
    v_add_f32 v113, v113, v49
    v_cvt_pk_bf16_f32 v113, v112, v113
    v_lshlrev_b32 v112, 16, v113
    v_and_b32 v113, 0xffff0000, v113
    v_add_f32 v112, v112, v56
    v_add_f32 v113, v113, v57
    v_cvt_pk_bf16_f32 v44, v112, v113
    v_cvt_pk_bf16_f32 v115, v114, v115
    v_lshlrev_b32 v114, 16, v115
    v_and_b32 v115, 0xffff0000, v115
    v_add_f32 v114, v114, v50
    v_add_f32 v115, v115, v51
    v_cvt_pk_bf16_f32 v115, v114, v115
    v_lshlrev_b32 v114, 16, v115
    v_and_b32 v115, 0xffff0000, v115
    v_add_f32 v114, v114, v58
    v_add_f32 v115, v115, v59
    v_cvt_pk_bf16_f32 v45, v114, v115
    v_cvt_pk_bf16_f32 v117, v116, v117
    v_lshlrev_b32 v116, 16, v117
    v_and_b32 v117, 0xffff0000, v117
    v_add_f32 v116, v116, v52
    v_add_f32 v117, v117, v53
    v_cvt_pk_bf16_f32 v117, v116, v117
    v_lshlrev_b32 v116, 16, v117
    v_and_b32 v117, 0xffff0000, v117
    v_add_f32 v116, v116, v60
    v_add_f32 v117, v117, v61
    v_cvt_pk_bf16_f32 v46, v116, v117
    v_cvt_pk_bf16_f32 v119, v118, v119
    v_lshlrev_b32 v118, 16, v119
    v_and_b32 v119, 0xffff0000, v119
    v_add_f32 v118, v118, v54
    v_add_f32 v119, v119, v55
    v_cvt_pk_bf16_f32 v119, v118, v119
    v_lshlrev_b32 v118, 16, v119
    v_and_b32 v119, 0xffff0000, v119
    v_add_f32 v118, v118, v62
    v_add_f32 v119, v119, v63
    v_cvt_pk_bf16_f32 v47, v118, v119
    buffer_store_dwordx4 v[44:47], v2, s[8:11], s14 offen sc1
    s_cmp_lg_u32 s54, 2
    s_cbranch_scc1 F1_TAIL
CONV_END:
    s_endpgm

.p2align 8
mlpa_kernel:
    s_mov_b32 s30, 8650752
    s_mov_b32 s31, 10747904
    s_mov_b32 s33, 65536
    s_mov_b32 s34, 131072
    s_mov_b32 s35, 0
    s_mov_b32 s56, 81920
M_BODY:
    s_cmp_ge_u32 s2, 256
    s_cbranch_scc1 M_END
    s_load_dwordx2 s[4:5], s[0:1], 104
    s_load_dwordx2 s[6:7], s[0:1], 88
    v_readfirstlane_b32 s17, v0
    s_and_b32 s12, s2, 7
    s_lshr_b32 s13, s2, 3
    s_lshr_b32 s14, s12, 1
    s_lshl_b32 s14, s14, 2
    s_and_b32 s15, s13, 3
    s_add_u32 s14, s14, s15
    s_lshl_b32 s36, s12, 2
    s_add_u32 s36, s36, s15
    s_lshr_b32 s37, s13, 2
    s_and_b32 s15, s12, 1
    s_lshl_b32 s15, s15, 3
    s_add_u32 s15, s15, s37
    s_lshr_b32 s17, s17, 6
    s_and_b32 s16, s17, 3
    s_lshr_b32 s29, s17, 2
    v_and_b32 v136, 63, v0
    v_and_b32 v137, 15, v0
    v_bfe_u32 v138, v0, 4, 2
    v_lshlrev_b32 v134, 4, v136
    v_lshlrev_b32 v135, 4, v136
    s_lshl_b32 s18, s14, 17
    s_add_u32 s18, s18, s30
    s_lshl_b32 s19, s17, 10
    s_add_u32 s18, s18, s19
    s_lshl_b32 s19, s17, 10
    s_lshl_b32 s20, s15, 2
    s_add_u32 s20, s20, s16
    s_lshl_b32 s21, s20, 4
    s_add_u32 s21, s21, s29
    s_mul_i32 s21, s21, 3072
    s_add_u32 s21, s21, 1572864
    s_mul_i32 s22, s17, 3072
    s_add_u32 s22, s22, 0x4000
    s_mul_i32 s24, s20, 192
    s_add_u32 s24, s24, 32768
    s_lshl_b32 s38, s37, 2
    s_add_u32 s38, s38, s16
    s_mul_i32 s38, s38, 45056
    s_mul_i32 s23, s29, 22528
    s_add_u32 s38, s38, s23
    s_add_u32 s38, s38, 4718592
    s_mov_b32 s43, 0x3b000000
    s_mov_b32 s44, 0x3727c5ac
    s_mov_b32 s45, 0xbfb8aa3b
    v_lshrrev_b32 v150, 2, v137
    v_lshl_add_u32 v150, v138, 2, v150
    v_and_b32 v151, 7, v150
    v_and_b32 v152, 3, v137
    v_lshlrev_b32 v152, 3, v152
    v_lshl_add_u32 v152, v150, 8, v152
    v_mul_u32_u24 v142, 4352, v137
    v_lshl_add_u32 v142, v138, 4, v142
    s_lshl_b32 s39, s37, 2
    s_add_u32 s39, s39, s16
    s_mul_i32 s39, s39, 69632
    s_lshl_b32 s40, s36, 7
    s_add_u32 s39, s39, s40
    s_lshl_b32 s40, s29, 6
    s_add_u32 s39, s39, s40
    s_lshr_b32 s40, s36, 1
    s_lshl_b32 s40, s40, 17
    s_add_u32 s40, s40, s30
    s_lshl_b32 s26, s37, 2
    s_add_u32 s26, s26, s16
    s_lshl_b32 s26, s26, 12
    s_add_u32 s40, s40, s26
    s_and_b32 s26, s36, 1
    s_lshl_b32 s26, s26, 1
    s_add_u32 s26, s26, s29
    s_lshl_b32 s26, s26, 1
    v_lshrrev_b32 v153, 1, v138
    v_add_u32 v153, s26, v153
    v_and_b32 v154, 7, v137
    v_xor_b32 v153, v153, v154
    v_lshlrev_b32 v153, 5, v153
    v_lshl_add_u32 v153, v137, 8, v153
    v_and_b32 v154, 1, v138
    v_lshl_add_u32 v159, v154, 4, v153
    s_lshl_b32 s25, s29, 2
    s_add_u32 s26, s25, 0
    v_xor_b32 v153, s26, v151
    v_lshl_add_u32 v104, v153, 5, v152
    v_add_u32 v108, 81920, v104
    s_add_u32 s26, s25, 1
    v_xor_b32 v153, s26, v151
    v_lshl_add_u32 v105, v153, 5, v152
    v_add_u32 v109, 81920, v105
    s_add_u32 s26, s25, 2
    v_xor_b32 v153, s26, v151
    v_lshl_add_u32 v106, v153, 5, v152
    v_add_u32 v110, 81920, v106
    s_add_u32 s26, s25, 3
    v_xor_b32 v153, s26, v151
    v_lshl_add_u32 v107, v153, 5, v152
    v_add_u32 v111, 81920, v107
    s_mul_i32 s26, s16, 3072
    s_add_u32 s26, s26, 0x4000
    v_add_u32 v112, s26, v135
    v_add_u32 v113, 81920, v112
    v_bfe_u32 v150, v137, 2, 1
    v_mul_u32_u24 v154, 3072, v150
    v_lshrrev_b32 v150, 3, v137
    v_lshl_add_u32 v154, v150, 6, v154
    v_and_b32 v150, 3, v137
    v_lshl_add_u32 v154, v150, 4, v154
    v_lshl_add_u32 v154, v138, 8, v154
    s_lshl_b32 s26, s16, 10
    s_cmp_eq_u32 s16, 3
    s_cselect_b32 s26, 12, s26
    s_cselect_b32 s27, 0x400, 4
    s_mul_i32 s28, s29, 12288
    s_add_u32 s26, s26, s28
    v_add_u32 v139, s26, v154
    v_add_u32 v140, s27, v139
    v_add_u32 v141, s27, v140
    v_lshlrev_b32 v143, 2, v137
    s_lshl_b32 s41, s14, 9
    s_lshl_b32 s26, s29, 8
    s_add_u32 s41, s41, s26
    s_add_u32 s41, s41, s33
    s_and_b32 s27, s17, 1
    s_and_b32 s28, s17, 2
    s_lshl_b32 s28, s28, 1
    s_or_b32 s27, s27, s28
    s_lshl_b32 s28, s29, 1
    s_or_b32 s27, s27, s28
    s_mul_i32 s26, s27, 3072
    v_add_u32 v144, s26, v135
    s_lshl_b32 s42, s14, 3
    s_add_u32 s42, s42, s27
    s_mul_i32 s42, s42, 46080
    s_mul_i32 s26, s15, 3072
    s_add_u32 s42, s42, s26
    s_add_u32 s42, s42, s31
    v_lshlrev_b32 v145, 4, v138
    v_lshrrev_b32 v156, 3, v136
    v_mul_u32_u24 v156, 4352, v156
    v_and_b32 v157, 7, v136
    v_lshl_add_u32 v156, v157, 5, v156
    s_lshl_b32 s46, s37, 3
    s_add_u32 s46, s46, s17
    s_mul_i32 s46, s46, 34816
    s_lshl_b32 s47, s14, 8
    s_add_u32 s46, s46, s47
    s_add_u32 s46, s46, s30
    s_waitcnt lgkmcnt(0)
    s_mov_b32 s8, s4
    s_and_b32 s9, s5, 0xffff
    s_mov_b32 s10, 0x10000000
    s_mov_b32 s11, 0x20000
    s_cmp_eq_u32 s15, 15
    s_cbranch_scc1 M_STATS
    s_add_u32 m0, s19, 0
    s_nop 0
    buffer_load_dwordx4 v134, s[8:11], s18 offen lds
    s_add_u32 s18, s18, 0x2000
    s_add_u32 m0, s22, 0
    s_nop 0
    buffer_load_dwordx4 v135, s[8:11], s21 offen lds
    buffer_load_dwordx4 v135, s[8:11], s21 offen offset:1024 lds
    buffer_load_dwordx4 v135, s[8:11], s21 offen offset:2048 lds
    s_add_u32 s21, s21, 0x1800
    s_add_u32 m0, s19, 8192
    s_nop 0
    buffer_load_dwordx4 v134, s[8:11], s18 offen lds
    s_add_u32 s18, s18, 0x2000
    s_add_u32 m0, s19, 40960
    s_nop 0
    buffer_load_dwordx4 v134, s[8:11], s18 offen lds
    s_add_u32 s18, s18, 0x2000
    s_add_u32 m0, s22, 40960
    s_nop 0
    buffer_load_dwordx4 v135, s[8:11], s21 offen lds
    buffer_load_dwordx4 v135, s[8:11], s21 offen offset:1024 lds
    buffer_load_dwordx4 v135, s[8:11], s21 offen offset:2048 lds
    s_add_u32 s21, s21, 0x1800
    s_add_u32 m0, s19, 49152
    s_nop 0
    buffer_load_dwordx4 v134, s[8:11], s18 offen lds
    s_add_u32 s18, s18, 0x2000
    s_waitcnt vmcnt(6)
    s_barrier
    ds_read_b128 v[64:67], v112 offset:0
    ds_read_b128 v[68:71], v112 offset:1024
    ds_read_b128 v[72:75], v112 offset:2048
    ds_read_b64_tr_b16 v[48:49], v104 offset:0
    ds_read_b64_tr_b16 v[50:51], v104 offset:4096
    ds_read_b64_tr_b16 v[52:53], v105 offset:0
    ds_read_b64_tr_b16 v[54:55], v105 offset:4096
    ds_read_b64_tr_b16 v[56:57], v106 offset:0
    ds_read_b64_tr_b16 v[58:59], v106 offset:4096
    ds_read_b64_tr_b16 v[60:61], v107 offset:0
    ds_read_b64_tr_b16 v[62:63], v107 offset:4096
    s_waitcnt vmcnt(5)
    s_barrier
    s_waitcnt lgkmcnt(0)
    v_mfma_f32_16x16x32_bf16 v[0:3], v[64:67], v[48:51], 0
    ds_read_b128 v[92:95], v112 offset:12288
    v_mfma_f32_16x16x32_bf16 v[4:7], v[68:71], v[48:51], 0
    ds_read_b128 v[96:99], v112 offset:13312
    s_add_u32 m0, s19, 81920
    s_nop 0
    buffer_load_dwordx4 v134, s[8:11], s18 offen lds
    s_add_u32 s18, s18, 0x2000
    v_mfma_f32_16x16x32_bf16 v[8:11], v[72:75], v[48:51], 0
    ds_read_b128 v[100:103], v112 offset:14336
    v_mfma_f32_16x16x32_bf16 v[12:15], v[64:67], v[52:55], 0
    ds_read_b64_tr_b16 v[76:77], v104 offset:8192
    s_add_u32 m0, s22, 81920
    s_nop 0
    buffer_load_dwordx4 v135, s[8:11], s21 offen lds
    v_mfma_f32_16x16x32_bf16 v[16:19], v[68:71], v[52:55], 0
    ds_read_b64_tr_b16 v[78:79], v104 offset:12288
    v_mfma_f32_16x16x32_bf16 v[20:23], v[72:75], v[52:55], 0
    ds_read_b64_tr_b16 v[80:81], v105 offset:8192
    buffer_load_dwordx4 v135, s[8:11], s21 offen offset:1024 lds
    v_mfma_f32_16x16x32_bf16 v[24:27], v[64:67], v[56:59], 0
    ds_read_b64_tr_b16 v[82:83], v105 offset:12288
    v_mfma_f32_16x16x32_bf16 v[28:31], v[68:71], v[56:59], 0
    ds_read_b64_tr_b16 v[84:85], v106 offset:8192
    buffer_load_dwordx4 v135, s[8:11], s21 offen offset:2048 lds
    s_add_u32 s21, s21, 0x1800
    v_mfma_f32_16x16x32_bf16 v[32:35], v[72:75], v[56:59], 0
    ds_read_b64_tr_b16 v[86:87], v106 offset:12288
    v_mfma_f32_16x16x32_bf16 v[36:39], v[64:67], v[60:63], 0
    ds_read_b64_tr_b16 v[88:89], v107 offset:8192
    s_add_u32 m0, s19, 90112
    s_nop 0
    buffer_load_dwordx4 v134, s[8:11], s18 offen lds
    s_add_u32 s18, s18, 0x2000
    v_mfma_f32_16x16x32_bf16 v[40:43], v[68:71], v[60:63], 0
    ds_read_b64_tr_b16 v[90:91], v107 offset:12288
    v_mfma_f32_16x16x32_bf16 v[44:47], v[72:75], v[60:63], 0
    s_waitcnt vmcnt(5)
    s_barrier
    s_waitcnt lgkmcnt(0)
    v_mfma_f32_16x16x32_bf16 v[0:3], v[92:95], v[76:79], v[0:3]
    ds_read_b128 v[64:67], v112 offset:40960
    v_mfma_f32_16x16x32_bf16 v[4:7], v[96:99], v[76:79], v[4:7]
    ds_read_b128 v[68:71], v112 offset:41984
    s_add_u32 m0, s19, 122880
    s_nop 0
    buffer_load_dwordx4 v134, s[8:11], s18 offen lds
    s_add_u32 s18, s18, 0x2000
    v_mfma_f32_16x16x32_bf16 v[8:11], v[100:103], v[76:79], v[8:11]
    ds_read_b128 v[72:75], v112 offset:43008
    v_mfma_f32_16x16x32_bf16 v[12:15], v[92:95], v[80:83], v[12:15]
    ds_read_b64_tr_b16 v[48:49], v104 offset:40960
    s_add_u32 m0, s22, 122880
    s_nop 0
    buffer_load_dwordx4 v135, s[8:11], s21 offen lds
    v_mfma_f32_16x16x32_bf16 v[16:19], v[96:99], v[80:83], v[16:19]
    ds_read_b64_tr_b16 v[50:51], v104 offset:45056
    v_mfma_f32_16x16x32_bf16 v[20:23], v[100:103], v[80:83], v[20:23]
    ds_read_b64_tr_b16 v[52:53], v105 offset:40960
    buffer_load_dwordx4 v135, s[8:11], s21 offen offset:1024 lds
    v_mfma_f32_16x16x32_bf16 v[24:27], v[92:95], v[84:87], v[24:27]
    ds_read_b64_tr_b16 v[54:55], v105 offset:45056
    v_mfma_f32_16x16x32_bf16 v[28:31], v[96:99], v[84:87], v[28:31]
    ds_read_b64_tr_b16 v[56:57], v106 offset:40960
    buffer_load_dwordx4 v135, s[8:11], s21 offen offset:2048 lds
    s_add_u32 s21, s21, 0x1800
    v_mfma_f32_16x16x32_bf16 v[32:35], v[100:103], v[84:87], v[32:35]
    ds_read_b64_tr_b16 v[58:59], v106 offset:45056
    v_mfma_f32_16x16x32_bf16 v[36:39], v[92:95], v[88:91], v[36:39]
    ds_read_b64_tr_b16 v[60:61], v107 offset:40960
    s_add_u32 m0, s19, 131072
    s_nop 0
    buffer_load_dwordx4 v134, s[8:11], s18 offen lds
    s_add_u32 s18, s18, 0x2000
    v_mfma_f32_16x16x32_bf16 v[40:43], v[96:99], v[88:91], v[40:43]
    ds_read_b64_tr_b16 v[62:63], v107 offset:45056
    v_mfma_f32_16x16x32_bf16 v[44:47], v[100:103], v[88:91], v[44:47]
    s_waitcnt vmcnt(5)
    s_barrier
    s_waitcnt lgkmcnt(0)
    v_mfma_f32_16x16x32_bf16 v[0:3], v[64:67], v[48:51], v[0:3]
    ds_read_b128 v[92:95], v112 offset:53248
    v_mfma_f32_16x16x32_bf16 v[4:7], v[68:71], v[48:51], v[4:7]
    ds_read_b128 v[96:99], v112 offset:54272
    s_add_u32 m0, s19, 0
    s_nop 0
    buffer_load_dwordx4 v134, s[8:11], s18 offen lds
    s_add_u32 s18, s18, 0x2000
    v_mfma_f32_16x16x32_bf16 v[8:11], v[72:75], v[48:51], v[8:11]
    ds_read_b128 v[100:103], v112 offset:55296
    v_mfma_f32_16x16x32_bf16 v[12:15], v[64:67], v[52:55], v[12:15]
    ds_read_b64_tr_b16 v[76:77], v104 offset:49152
    v_mfma_f32_16x16x32_bf16 v[16:19], v[68:71], v[52:55], v[16:19]
    ds_read_b64_tr_b16 v[78:79], v104 offset:53248
    v_mfma_f32_16x16x32_bf16 v[20:23], v[72:75], v[52:55], v[20:23]
    ds_read_b64_tr_b16 v[80:81], v105 offset:49152
    s_add_u32 m0, s22, 0
    s_nop 0
    buffer_load_dwordx4 v135, s[8:11], s21 offen lds
    v_mfma_f32_16x16x32_bf16 v[24:27], v[64:67], v[56:59], v[24:27]
    ds_read_b64_tr_b16 v[82:83], v105 offset:53248
    v_mfma_f32_16x16x32_bf16 v[28:31], v[68:71], v[56:59], v[28:31]
    ds_read_b64_tr_b16 v[84:85], v106 offset:49152
    v_mfma_f32_16x16x32_bf16 v[32:35], v[72:75], v[56:59], v[32:35]
    ds_read_b64_tr_b16 v[86:87], v106 offset:53248
    v_mfma_f32_16x16x32_bf16 v[36:39], v[64:67], v[60:63], v[36:39]
    ds_read_b64_tr_b16 v[88:89], v107 offset:49152
    buffer_load_dwordx4 v135, s[8:11], s21 offen offset:1024 lds
    v_mfma_f32_16x16x32_bf16 v[40:43], v[68:71], v[60:63], v[40:43]
    ds_read_b64_tr_b16 v[90:91], v107 offset:53248
    v_mfma_f32_16x16x32_bf16 v[44:47], v[72:75], v[60:63], v[44:47]
    s_waitcnt lgkmcnt(0)
    v_mfma_f32_16x16x32_bf16 v[0:3], v[92:95], v[76:79], v[0:3]
    ds_read_b128 v[64:67], v113 offset:0
    v_mfma_f32_16x16x32_bf16 v[4:7], v[96:99], v[76:79], v[4:7]
    ds_read_b128 v[68:71], v113 offset:1024
    buffer_load_dwordx4 v135, s[8:11], s21 offen offset:2048 lds
    s_add_u32 s21, s21, 0x1800
    v_mfma_f32_16x16x32_bf16 v[8:11], v[100:103], v[76:79], v[8:11]
    ds_read_b128 v[72:75], v113 offset:2048
    v_mfma_f32_16x16x32_bf16 v[12:15], v[92:95], v[80:83], v[12:15]
    ds_read_b64_tr_b16 v[48:49], v108 offset:0
    v_mfma_f32_16x16x32_bf16 v[16:19], v[96:99], v[80:83], v[16:19]
    ds_read_b64_tr_b16 v[50:51], v108 offset:4096
    v_mfma_f32_16x16x32_bf16 v[20:23], v[100:103], v[80:83], v[20:23]
    ds_read_b64_tr_b16 v[52:53], v109 offset:0
    v_mfma_f32_16x16x32_bf16 v[24:27], v[92:95], v[84:87], v[24:27]
    ds_read_b64_tr_b16 v[54:55], v109 offset:4096
    v_mfma_f32_16x16x32_bf16 v[28:31], v[96:99], v[84:87], v[28:31]
    ds_read_b64_tr_b16 v[56:57], v110 offset:0
    s_add_u32 m0, s19, 8192
    s_nop 0
    buffer_load_dwordx4 v134, s[8:11], s18 offen lds
    s_add_u32 s18, s18, 0x2000
    v_mfma_f32_16x16x32_bf16 v[32:35], v[100:103], v[84:87], v[32:35]
    ds_read_b64_tr_b16 v[58:59], v110 offset:4096
    v_mfma_f32_16x16x32_bf16 v[36:39], v[92:95], v[88:91], v[36:39]
    ds_read_b64_tr_b16 v[60:61], v111 offset:0
    v_mfma_f32_16x16x32_bf16 v[40:43], v[96:99], v[88:91], v[40:43]
    ds_read_b64_tr_b16 v[62:63], v111 offset:4096
    v_mfma_f32_16x16x32_bf16 v[44:47], v[100:103], v[88:91], v[44:47]
    s_waitcnt vmcnt(5)
    s_barrier
    s_waitcnt lgkmcnt(0)
    v_mfma_f32_16x16x32_bf16 v[0:3], v[64:67], v[48:51], v[0:3]
    ds_read_b128 v[92:95], v113 offset:12288
    v_mfma_f32_16x16x32_bf16 v[4:7], v[68:71], v[48:51], v[4:7]
    ds_read_b128 v[96:99], v113 offset:13312
    s_add_u32 m0, s19, 40960
    s_nop 0
    buffer_load_dwordx4 v134, s[8:11], s18 offen lds
    s_add_u32 s18, s18, 0x2000
    v_mfma_f32_16x16x32_bf16 v[8:11], v[72:75], v[48:51], v[8:11]
    ds_read_b128 v[100:103], v113 offset:14336
    v_mfma_f32_16x16x32_bf16 v[12:15], v[64:67], v[52:55], v[12:15]
    ds_read_b64_tr_b16 v[76:77], v108 offset:8192
    v_mfma_f32_16x16x32_bf16 v[16:19], v[68:71], v[52:55], v[16:19]
    ds_read_b64_tr_b16 v[78:79], v108 offset:12288
    v_mfma_f32_16x16x32_bf16 v[20:23], v[72:75], v[52:55], v[20:23]
    ds_read_b64_tr_b16 v[80:81], v109 offset:8192
    s_add_u32 m0, s22, 40960
    s_nop 0
    buffer_load_dwordx4 v135, s[8:11], s21 offen lds
    v_mfma_f32_16x16x32_bf16 v[24:27], v[64:67], v[56:59], v[24:27]
    ds_read_b64_tr_b16 v[82:83], v109 offset:12288
    v_mfma_f32_16x16x32_bf16 v[28:31], v[68:71], v[56:59], v[28:31]
    ds_read_b64_tr_b16 v[84:85], v110 offset:8192
    v_mfma_f32_16x16x32_bf16 v[32:35], v[72:75], v[56:59], v[32:35]
    ds_read_b64_tr_b16 v[86:87], v110 offset:12288
    v_mfma_f32_16x16x32_bf16 v[36:39], v[64:67], v[60:63], v[36:39]
    ds_read_b64_tr_b16 v[88:89], v111 offset:8192
    buffer_load_dwordx4 v135, s[8:11], s21 offen offset:1024 lds
    v_mfma_f32_16x16x32_bf16 v[40:43], v[68:71], v[60:63], v[40:43]
    ds_read_b64_tr_b16 v[90:91], v111 offset:12288
    v_mfma_f32_16x16x32_bf16 v[44:47], v[72:75], v[60:63], v[44:47]
    s_waitcnt lgkmcnt(0)
    v_mfma_f32_16x16x32_bf16 v[0:3], v[92:95], v[76:79], v[0:3]
    ds_read_b128 v[64:67], v113 offset:40960
    v_mfma_f32_16x16x32_bf16 v[4:7], v[96:99], v[76:79], v[4:7]
    ds_read_b128 v[68:71], v113 offset:41984
    buffer_load_dwordx4 v135, s[8:11], s21 offen offset:2048 lds
    s_add_u32 s21, s21, 0x1800
    v_mfma_f32_16x16x32_bf16 v[8:11], v[100:103], v[76:79], v[8:11]
    ds_read_b128 v[72:75], v113 offset:43008
    v_mfma_f32_16x16x32_bf16 v[12:15], v[92:95], v[80:83], v[12:15]
    ds_read_b64_tr_b16 v[48:49], v108 offset:40960
    v_mfma_f32_16x16x32_bf16 v[16:19], v[96:99], v[80:83], v[16:19]
    ds_read_b64_tr_b16 v[50:51], v108 offset:45056
    v_mfma_f32_16x16x32_bf16 v[20:23], v[100:103], v[80:83], v[20:23]
    ds_read_b64_tr_b16 v[52:53], v109 offset:40960
    v_mfma_f32_16x16x32_bf16 v[24:27], v[92:95], v[84:87], v[24:27]
    ds_read_b64_tr_b16 v[54:55], v109 offset:45056
    v_mfma_f32_16x16x32_bf16 v[28:31], v[96:99], v[84:87], v[28:31]
    ds_read_b64_tr_b16 v[56:57], v110 offset:40960
    s_add_u32 m0, s19, 49152
    s_nop 0
    buffer_load_dwordx4 v134, s[8:11], s18 offen lds
    s_add_u32 s18, s18, 0x2000
    v_mfma_f32_16x16x32_bf16 v[32:35], v[100:103], v[84:87], v[32:35]
    ds_read_b64_tr_b16 v[58:59], v110 offset:45056
    v_mfma_f32_16x16x32_bf16 v[36:39], v[92:95], v[88:91], v[36:39]
    ds_read_b64_tr_b16 v[60:61], v111 offset:40960
    v_mfma_f32_16x16x32_bf16 v[40:43], v[96:99], v[88:91], v[40:43]
    ds_read_b64_tr_b16 v[62:63], v111 offset:45056
    v_mfma_f32_16x16x32_bf16 v[44:47], v[100:103], v[88:91], v[44:47]
    s_waitcnt vmcnt(5)
    s_barrier
    s_waitcnt lgkmcnt(0)
    v_mfma_f32_16x16x32_bf16 v[0:3], v[64:67], v[48:51], v[0:3]
    ds_read_b128 v[92:95], v113 offset:53248
    v_mfma_f32_16x16x32_bf16 v[4:7], v[68:71], v[48:51], v[4:7]
    ds_read_b128 v[96:99], v113 offset:54272
    s_add_u32 m0, s19, 81920
    s_nop 0
    buffer_load_dwordx4 v134, s[8:11], s18 offen lds
    s_add_u32 s18, s18, 0x2000
    v_mfma_f32_16x16x32_bf16 v[8:11], v[72:75], v[48:51], v[8:11]
    ds_read_b128 v[100:103], v113 offset:55296
    v_mfma_f32_16x16x32_bf16 v[12:15], v[64:67], v[52:55], v[12:15]
    ds_read_b64_tr_b16 v[76:77], v108 offset:49152
    v_mfma_f32_16x16x32_bf16 v[16:19], v[68:71], v[52:55], v[16:19]
    ds_read_b64_tr_b16 v[78:79], v108 offset:53248
    v_mfma_f32_16x16x32_bf16 v[20:23], v[72:75], v[52:55], v[20:23]
    ds_read_b64_tr_b16 v[80:81], v109 offset:49152
    s_add_u32 m0, s22, 81920
    s_nop 0
    buffer_load_dwordx4 v135, s[8:11], s21 offen lds
    v_mfma_f32_16x16x32_bf16 v[24:27], v[64:67], v[56:59], v[24:27]
    ds_read_b64_tr_b16 v[82:83], v109 offset:53248
    v_mfma_f32_16x16x32_bf16 v[28:31], v[68:71], v[56:59], v[28:31]
    ds_read_b64_tr_b16 v[84:85], v110 offset:49152
    v_mfma_f32_16x16x32_bf16 v[32:35], v[72:75], v[56:59], v[32:35]
    ds_read_b64_tr_b16 v[86:87], v110 offset:53248
    v_mfma_f32_16x16x32_bf16 v[36:39], v[64:67], v[60:63], v[36:39]
    ds_read_b64_tr_b16 v[88:89], v111 offset:49152
    buffer_load_dwordx4 v135, s[8:11], s21 offen offset:1024 lds
    v_mfma_f32_16x16x32_bf16 v[40:43], v[68:71], v[60:63], v[40:43]
    ds_read_b64_tr_b16 v[90:91], v111 offset:53248
    v_mfma_f32_16x16x32_bf16 v[44:47], v[72:75], v[60:63], v[44:47]
    s_waitcnt lgkmcnt(0)
    v_mfma_f32_16x16x32_bf16 v[0:3], v[92:95], v[76:79], v[0:3]
    ds_read_b128 v[64:67], v112 offset:0
    v_mfma_f32_16x16x32_bf16 v[4:7], v[96:99], v[76:79], v[4:7]
    ds_read_b128 v[68:71], v112 offset:1024
    buffer_load_dwordx4 v135, s[8:11], s21 offen offset:2048 lds
    s_add_u32 s21, s21, 0x1800
    v_mfma_f32_16x16x32_bf16 v[8:11], v[100:103], v[76:79], v[8:11]
    ds_read_b128 v[72:75], v112 offset:2048
    v_mfma_f32_16x16x32_bf16 v[12:15], v[92:95], v[80:83], v[12:15]
    ds_read_b64_tr_b16 v[48:49], v104 offset:0
    v_mfma_f32_16x16x32_bf16 v[16:19], v[96:99], v[80:83], v[16:19]
    ds_read_b64_tr_b16 v[50:51], v104 offset:4096
    v_mfma_f32_16x16x32_bf16 v[20:23], v[100:103], v[80:83], v[20:23]
    ds_read_b64_tr_b16 v[52:53], v105 offset:0
    v_mfma_f32_16x16x32_bf16 v[24:27], v[92:95], v[84:87], v[24:27]
    ds_read_b64_tr_b16 v[54:55], v105 offset:4096
    v_mfma_f32_16x16x32_bf16 v[28:31], v[96:99], v[84:87], v[28:31]
    ds_read_b64_tr_b16 v[56:57], v106 offset:0
    s_add_u32 m0, s19, 90112
    s_nop 0
    buffer_load_dwordx4 v134, s[8:11], s18 offen lds
    s_add_u32 s18, s18, 0x2000
    v_mfma_f32_16x16x32_bf16 v[32:35], v[100:103], v[84:87], v[32:35]
    ds_read_b64_tr_b16 v[58:59], v106 offset:4096
    v_mfma_f32_16x16x32_bf16 v[36:39], v[92:95], v[88:91], v[36:39]
    ds_read_b64_tr_b16 v[60:61], v107 offset:0
    v_mfma_f32_16x16x32_bf16 v[40:43], v[96:99], v[88:91], v[40:43]
    ds_read_b64_tr_b16 v[62:63], v107 offset:4096
    v_mfma_f32_16x16x32_bf16 v[44:47], v[100:103], v[88:91], v[44:47]
    s_waitcnt vmcnt(5)
    s_barrier
    s_waitcnt lgkmcnt(0)
    v_mfma_f32_16x16x32_bf16 v[0:3], v[64:67], v[48:51], v[0:3]
    ds_read_b128 v[92:95], v112 offset:12288
    v_mfma_f32_16x16x32_bf16 v[4:7], v[68:71], v[48:51], v[4:7]
    ds_read_b128 v[96:99], v112 offset:13312
    s_add_u32 m0, s19, 122880
    s_nop 0
    buffer_load_dwordx4 v134, s[8:11], s18 offen lds
    s_add_u32 s18, s18, 0x2000
    v_mfma_f32_16x16x32_bf16 v[8:11], v[72:75], v[48:51], v[8:11]
    ds_read_b128 v[100:103], v112 offset:14336
    v_mfma_f32_16x16x32_bf16 v[12:15], v[64:67], v[52:55], v[12:15]
    ds_read_b64_tr_b16 v[76:77], v104 offset:8192
    v_mfma_f32_16x16x32_bf16 v[16:19], v[68:71], v[52:55], v[16:19]
    ds_read_b64_tr_b16 v[78:79], v104 offset:12288
    v_mfma_f32_16x16x32_bf16 v[20:23], v[72:75], v[52:55], v[20:23]
    ds_read_b64_tr_b16 v[80:81], v105 offset:8192
    s_add_u32 m0, s22, 122880
    s_nop 0
    buffer_load_dwordx4 v135, s[8:11], s21 offen lds
    v_mfma_f32_16x16x32_bf16 v[24:27], v[64:67], v[56:59], v[24:27]
    ds_read_b64_tr_b16 v[82:83], v105 offset:12288
    v_mfma_f32_16x16x32_bf16 v[28:31], v[68:71], v[56:59], v[28:31]
    ds_read_b64_tr_b16 v[84:85], v106 offset:8192
    v_mfma_f32_16x16x32_bf16 v[32:35], v[72:75], v[56:59], v[32:35]
    ds_read_b64_tr_b16 v[86:87], v106 offset:12288
    v_mfma_f32_16x16x32_bf16 v[36:39], v[64:67], v[60:63], v[36:39]
    ds_read_b64_tr_b16 v[88:89], v107 offset:8192
    buffer_load_dwordx4 v135, s[8:11], s21 offen offset:1024 lds
    v_mfma_f32_16x16x32_bf16 v[40:43], v[68:71], v[60:63], v[40:43]
    ds_read_b64_tr_b16 v[90:91], v107 offset:12288
    v_mfma_f32_16x16x32_bf16 v[44:47], v[72:75], v[60:63], v[44:47]
    s_waitcnt lgkmcnt(0)
    v_mfma_f32_16x16x32_bf16 v[0:3], v[92:95], v[76:79], v[0:3]
    ds_read_b128 v[64:67], v112 offset:40960
    v_mfma_f32_16x16x32_bf16 v[4:7], v[96:99], v[76:79], v[4:7]
    ds_read_b128 v[68:71], v112 offset:41984
    buffer_load_dwordx4 v135, s[8:11], s21 offen offset:2048 lds
    s_add_u32 s21, s21, 0x1800
    v_mfma_f32_16x16x32_bf16 v[8:11], v[100:103], v[76:79], v[8:11]
    ds_read_b128 v[72:75], v112 offset:43008
    v_mfma_f32_16x16x32_bf16 v[12:15], v[92:95], v[80:83], v[12:15]
    ds_read_b64_tr_b16 v[48:49], v104 offset:40960
    v_mfma_f32_16x16x32_bf16 v[16:19], v[96:99], v[80:83], v[16:19]
    ds_read_b64_tr_b16 v[50:51], v104 offset:45056
    v_mfma_f32_16x16x32_bf16 v[20:23], v[100:103], v[80:83], v[20:23]
    ds_read_b64_tr_b16 v[52:53], v105 offset:40960
    s_add_u32 m0, s19, 131072
    s_nop 0
    buffer_load_dwordx4 v134, s[8:11], s18 offen lds
    s_add_u32 s18, s18, 0x2000
    v_mfma_f32_16x16x32_bf16 v[24:27], v[92:95], v[84:87], v[24:27]
    ds_read_b64_tr_b16 v[54:55], v105 offset:45056
    v_mfma_f32_16x16x32_bf16 v[28:31], v[96:99], v[84:87], v[28:31]
    ds_read_b64_tr_b16 v[56:57], v106 offset:40960
    v_mfma_f32_16x16x32_bf16 v[32:35], v[100:103], v[84:87], v[32:35]
    ds_read_b64_tr_b16 v[58:59], v106 offset:45056
    v_mfma_f32_16x16x32_bf16 v[36:39], v[92:95], v[88:91], v[36:39]
    ds_read_b64_tr_b16 v[60:61], v107 offset:40960
    buffer_load_dwordx4 v[114:117], v145, s[8:11], s24 offen offset:0
    v_mfma_f32_16x16x32_bf16 v[40:43], v[96:99], v[88:91], v[40:43]
    ds_read_b64_tr_b16 v[62:63], v107 offset:45056
    v_mfma_f32_16x16x32_bf16 v[44:47], v[100:103], v[88:91], v[44:47]
    s_waitcnt vmcnt(6)
    s_barrier
    s_waitcnt lgkmcnt(0)
    v_mfma_f32_16x16x32_bf16 v[0:3], v[64:67], v[48:51], v[0:3]
    ds_read_b128 v[92:95], v112 offset:53248
    v_mfma_f32_16x16x32_bf16 v[4:7], v[68:71], v[48:51], v[4:7]
    ds_read_b128 v[96:99], v112 offset:54272
    buffer_load_dwordx4 v[118:121], v145, s[8:11], s24 offen offset:64
    v_mfma_f32_16x16x32_bf16 v[8:11], v[72:75], v[48:51], v[8:11]
    ds_read_b128 v[100:103], v112 offset:55296
    v_mfma_f32_16x16x32_bf16 v[12:15], v[64:67], v[52:55], v[12:15]
    ds_read_b64_tr_b16 v[76:77], v104 offset:49152
    v_mfma_f32_16x16x32_bf16 v[16:19], v[68:71], v[52:55], v[16:19]
    ds_read_b64_tr_b16 v[78:79], v104 offset:53248
    v_mfma_f32_16x16x32_bf16 v[20:23], v[72:75], v[52:55], v[20:23]
    ds_read_b64_tr_b16 v[80:81], v105 offset:49152
    buffer_load_dwordx4 v[122:125], v145, s[8:11], s24 offen offset:128
    v_mfma_f32_16x16x32_bf16 v[24:27], v[64:67], v[56:59], v[24:27]
    ds_read_b64_tr_b16 v[82:83], v105 offset:53248
    v_mfma_f32_16x16x32_bf16 v[28:31], v[68:71], v[56:59], v[28:31]
    ds_read_b64_tr_b16 v[84:85], v106 offset:49152
    v_mfma_f32_16x16x32_bf16 v[32:35], v[72:75], v[56:59], v[32:35]
    ds_read_b64_tr_b16 v[86:87], v106 offset:53248
    v_mfma_f32_16x16x32_bf16 v[36:39], v[64:67], v[60:63], v[36:39]
    ds_read_b64_tr_b16 v[88:89], v107 offset:49152
    buffer_load_dwordx4 v[130:133], v159, s[8:11], s40 offen
    v_mfma_f32_16x16x32_bf16 v[40:43], v[68:71], v[60:63], v[40:43]
    ds_read_b64_tr_b16 v[90:91], v107 offset:53248
    v_mfma_f32_16x16x32_bf16 v[44:47], v[72:75], v[60:63], v[44:47]
    s_waitcnt lgkmcnt(0)
    v_mfma_f32_16x16x32_bf16 v[0:3], v[92:95], v[76:79], v[0:3]
    ds_read_b128 v[64:67], v113 offset:0
    v_mfma_f32_16x16x32_bf16 v[4:7], v[96:99], v[76:79], v[4:7]
    ds_read_b128 v[68:71], v113 offset:1024
    buffer_load_dword v126, v143, s[8:11], s41 offen offset:0 sc1
    v_mfma_f32_16x16x32_bf16 v[8:11], v[100:103], v[76:79], v[8:11]
    ds_read_b128 v[72:75], v113 offset:2048
    v_mfma_f32_16x16x32_bf16 v[12:15], v[92:95], v[80:83], v[12:15]
    ds_read_b64_tr_b16 v[48:49], v108 offset:0
    v_mfma_f32_16x16x32_bf16 v[16:19], v[96:99], v[80:83], v[16:19]
    ds_read_b64_tr_b16 v[50:51], v108 offset:4096
    v_mfma_f32_16x16x32_bf16 v[20:23], v[100:103], v[80:83], v[20:23]
    ds_read_b64_tr_b16 v[52:53], v109 offset:0
    buffer_load_dword v127, v143, s[8:11], s41 offen offset:64 sc1
    v_mfma_f32_16x16x32_bf16 v[24:27], v[92:95], v[84:87], v[24:27]
    ds_read_b64_tr_b16 v[54:55], v109 offset:4096
    v_mfma_f32_16x16x32_bf16 v[28:31], v[96:99], v[84:87], v[28:31]
    ds_read_b64_tr_b16 v[56:57], v110 offset:0
    v_mfma_f32_16x16x32_bf16 v[32:35], v[100:103], v[84:87], v[32:35]
    ds_read_b64_tr_b16 v[58:59], v110 offset:4096
    v_mfma_f32_16x16x32_bf16 v[36:39], v[92:95], v[88:91], v[36:39]
    ds_read_b64_tr_b16 v[60:61], v111 offset:0
    buffer_load_dword v128, v143, s[8:11], s41 offen offset:128 sc1
    v_mfma_f32_16x16x32_bf16 v[40:43], v[96:99], v[88:91], v[40:43]
    ds_read_b64_tr_b16 v[62:63], v111 offset:4096
    v_mfma_f32_16x16x32_bf16 v[44:47], v[100:103], v[88:91], v[44:47]
    s_waitcnt vmcnt(7)
    s_barrier
    s_waitcnt lgkmcnt(0)
    v_mfma_f32_16x16x32_bf16 v[0:3], v[64:67], v[48:51], v[0:3]
    ds_read_b128 v[92:95], v113 offset:12288
    v_mfma_f32_16x16x32_bf16 v[4:7], v[68:71], v[48:51], v[4:7]
    ds_read_b128 v[96:99], v113 offset:13312
    buffer_load_dword v129, v143, s[8:11], s41 offen offset:192 sc1
    v_mfma_f32_16x16x32_bf16 v[8:11], v[72:75], v[48:51], v[8:11]
    ds_read_b128 v[100:103], v113 offset:14336
    v_mfma_f32_16x16x32_bf16 v[12:15], v[64:67], v[52:55], v[12:15]
    ds_read_b64_tr_b16 v[76:77], v108 offset:8192
    buffer_load_dwordx4 a[0:3], v135, s[8:11], s38 offen offset:0
    v_mfma_f32_16x16x32_bf16 v[16:19], v[68:71], v[52:55], v[16:19]
    ds_read_b64_tr_b16 v[78:79], v108 offset:12288
    v_mfma_f32_16x16x32_bf16 v[20:23], v[72:75], v[52:55], v[20:23]
    ds_read_b64_tr_b16 v[80:81], v109 offset:8192
    buffer_load_dwordx4 a[4:7], v135, s[8:11], s38 offen offset:1024
    v_mfma_f32_16x16x32_bf16 v[24:27], v[64:67], v[56:59], v[24:27]
    ds_read_b64_tr_b16 v[82:83], v109 offset:12288
    v_mfma_f32_16x16x32_bf16 v[28:31], v[68:71], v[56:59], v[28:31]
    ds_read_b64_tr_b16 v[84:85], v110 offset:8192
    buffer_load_dwordx4 a[8:11], v135, s[8:11], s38 offen offset:2048
    v_mfma_f32_16x16x32_bf16 v[32:35], v[72:75], v[56:59], v[32:35]
    ds_read_b64_tr_b16 v[86:87], v110 offset:12288
    v_mfma_f32_16x16x32_bf16 v[36:39], v[64:67], v[60:63], v[36:39]
    ds_read_b64_tr_b16 v[88:89], v111 offset:8192
    buffer_load_dwordx4 a[12:15], v135, s[8:11], s38 offen offset:3072
    s_add_u32 s38, s38, 0x1000
    v_mfma_f32_16x16x32_bf16 v[40:43], v[68:71], v[60:63], v[40:43]
    ds_read_b64_tr_b16 v[90:91], v111 offset:12288
    v_mfma_f32_16x16x32_bf16 v[44:47], v[72:75], v[60:63], v[44:47]
    s_waitcnt lgkmcnt(0)
    v_mfma_f32_16x16x32_bf16 v[0:3], v[92:95], v[76:79], v[0:3]
    ds_read_b128 v[64:67], v113 offset:40960
    v_mfma_f32_16x16x32_bf16 v[4:7], v[96:99], v[76:79], v[4:7]
    ds_read_b128 v[68:71], v113 offset:41984
    buffer_load_dwordx4 a[16:19], v135, s[8:11], s38 offen offset:0
    v_mfma_f32_16x16x32_bf16 v[8:11], v[100:103], v[76:79], v[8:11]
    ds_read_b128 v[72:75], v113 offset:43008
    v_mfma_f32_16x16x32_bf16 v[12:15], v[92:95], v[80:83], v[12:15]
    ds_read_b64_tr_b16 v[48:49], v108 offset:40960
    v_mfma_f32_16x16x32_bf16 v[16:19], v[96:99], v[80:83], v[16:19]
    ds_read_b64_tr_b16 v[50:51], v108 offset:45056
    v_mfma_f32_16x16x32_bf16 v[20:23], v[100:103], v[80:83], v[20:23]
    ds_read_b64_tr_b16 v[52:53], v109 offset:40960
    v_mfma_f32_16x16x32_bf16 v[24:27], v[92:95], v[84:87], v[24:27]
    ds_read_b64_tr_b16 v[54:55], v109 offset:45056
    v_mfma_f32_16x16x32_bf16 v[28:31], v[96:99], v[84:87], v[28:31]
    ds_read_b64_tr_b16 v[56:57], v110 offset:40960
    buffer_load_dwordx4 a[20:23], v135, s[8:11], s38 offen offset:1024
    v_mfma_f32_16x16x32_bf16 v[32:35], v[100:103], v[84:87], v[32:35]
    ds_read_b64_tr_b16 v[58:59], v110 offset:45056
    v_mfma_f32_16x16x32_bf16 v[36:39], v[92:95], v[88:91], v[36:39]
    ds_read_b64_tr_b16 v[60:61], v111 offset:40960
    v_mfma_f32_16x16x32_bf16 v[40:43], v[96:99], v[88:91], v[40:43]
    ds_read_b64_tr_b16 v[62:63], v111 offset:45056
    v_mfma_f32_16x16x32_bf16 v[44:47], v[100:103], v[88:91], v[44:47]
    s_waitcnt lgkmcnt(0)
    v_mfma_f32_16x16x32_bf16 v[0:3], v[64:67], v[48:51], v[0:3]
    ds_read_b128 v[92:95], v113 offset:53248
    v_mfma_f32_16x16x32_bf16 v[4:7], v[68:71], v[48:51], v[4:7]
    ds_read_b128 v[96:99], v113 offset:54272
    v_mfma_f32_16x16x32_bf16 v[8:11], v[72:75], v[48:51], v[8:11]
    ds_read_b128 v[100:103], v113 offset:55296
    v_mfma_f32_16x16x32_bf16 v[12:15], v[64:67], v[52:55], v[12:15]
    ds_read_b64_tr_b16 v[76:77], v108 offset:49152
    v_mfma_f32_16x16x32_bf16 v[16:19], v[68:71], v[52:55], v[16:19]
    ds_read_b64_tr_b16 v[78:79], v108 offset:53248
    v_mfma_f32_16x16x32_bf16 v[20:23], v[72:75], v[52:55], v[20:23]
    ds_read_b64_tr_b16 v[80:81], v109 offset:49152
    v_mfma_f32_16x16x32_bf16 v[24:27], v[64:67], v[56:59], v[24:27]
    ds_read_b64_tr_b16 v[82:83], v109 offset:53248
    v_mfma_f32_16x16x32_bf16 v[28:31], v[68:71], v[56:59], v[28:31]
    ds_read_b64_tr_b16 v[84:85], v110 offset:49152
    v_mfma_f32_16x16x32_bf16 v[32:35], v[72:75], v[56:59], v[32:35]
    ds_read_b64_tr_b16 v[86:87], v110 offset:53248
    v_mfma_f32_16x16x32_bf16 v[36:39], v[64:67], v[60:63], v[36:39]
    ds_read_b64_tr_b16 v[88:89], v111 offset:49152
    v_mfma_f32_16x16x32_bf16 v[40:43], v[68:71], v[60:63], v[40:43]
    ds_read_b64_tr_b16 v[90:91], v111 offset:53248
    v_mfma_f32_16x16x32_bf16 v[44:47], v[72:75], v[60:63], v[44:47]
    s_waitcnt lgkmcnt(0)
    v_mfma_f32_16x16x32_bf16 v[0:3], v[92:95], v[76:79], v[0:3]
    v_mfma_f32_16x16x32_bf16 v[4:7], v[96:99], v[76:79], v[4:7]
    v_mfma_f32_16x16x32_bf16 v[8:11], v[100:103], v[76:79], v[8:11]
    v_mfma_f32_16x16x32_bf16 v[12:15], v[92:95], v[80:83], v[12:15]
    v_mfma_f32_16x16x32_bf16 v[16:19], v[96:99], v[80:83], v[16:19]
    v_mfma_f32_16x16x32_bf16 v[20:23], v[100:103], v[80:83], v[20:23]
    v_mfma_f32_16x16x32_bf16 v[24:27], v[92:95], v[84:87], v[24:27]
    v_mfma_f32_16x16x32_bf16 v[28:31], v[96:99], v[84:87], v[28:31]
    v_mfma_f32_16x16x32_bf16 v[32:35], v[100:103], v[84:87], v[32:35]
    v_mfma_f32_16x16x32_bf16 v[36:39], v[92:95], v[88:91], v[36:39]
    v_mfma_f32_16x16x32_bf16 v[40:43], v[96:99], v[88:91], v[40:43]
    v_mfma_f32_16x16x32_bf16 v[44:47], v[100:103], v[88:91], v[44:47]
    s_waitcnt vmcnt(6)
    s_mov_b32 s47, 0
M_STCHK:
    v_min3_u32 v150, v126, v127, v128
    v_min_u32 v150, v150, v129
    v_cmp_eq_u32 vcc, 0, v150
    s_nop 0
    s_cmp_eq_u64 vcc, 0
    s_cbranch_scc1 M_STOK
    s_add_u32 s47, s47, 1
    s_cmp_ge_u32 s47, 1048576
    s_cbranch_scc1 M_STOK
    s_sleep 2
    buffer_load_dword v126, v143, s[8:11], s41 offen offset:0 sc1
    buffer_load_dword v127, v143, s[8:11], s41 offen offset:64 sc1
    buffer_load_dword v128, v143, s[8:11], s41 offen offset:128 sc1
    buffer_load_dword v129, v143, s[8:11], s41 offen offset:192 sc1
    s_waitcnt vmcnt(0)
    s_branch M_STCHK
M_STOK:
    v_and_b32 v148, 0xffff0000, v126
    v_lshlrev_b32 v146, 16, v126
    v_rcp_f32 v147, v148
    s_nop 0
    v_mul_f32 v147, s45, v147
    v_pk_fma_f32 v[0:1], v[146:147], v[114:115], v[0:1] op_sel_hi:[0,1,1] neg_lo:[1,0,0] neg_hi:[1,0,0]
    v_pk_fma_f32 v[2:3], v[146:147], v[116:117], v[2:3] op_sel_hi:[0,1,1] neg_lo:[1,0,0] neg_hi:[1,0,0]
    v_pk_mul_f32 v[0:1], v[0:1], v[146:147] op_sel:[0,1] op_sel_hi:[1,1]
    v_exp_f32 v0, v0
    v_exp_f32 v1, v1
    buffer_load_dwordx4 a[24:27], v135, s[8:11], s38 offen offset:2048
    v_pk_fma_f32 v[4:5], v[146:147], v[118:119], v[4:5] op_sel_hi:[0,1,1] neg_lo:[1,0,0] neg_hi:[1,0,0]
    v_pk_fma_f32 v[6:7], v[146:147], v[120:121], v[6:7] op_sel_hi:[0,1,1] neg_lo:[1,0,0] neg_hi:[1,0,0]
    v_pk_mul_f32 v[4:5], v[4:5], v[146:147] op_sel:[0,1] op_sel_hi:[1,1]
    v_exp_f32 v4, v4
    v_exp_f32 v5, v5
    buffer_load_dwordx4 a[28:31], v135, s[8:11], s38 offen offset:3072
    s_add_u32 s38, s38, 0x1000
    v_pk_fma_f32 v[8:9], v[146:147], v[122:123], v[8:9] op_sel_hi:[0,1,1] neg_lo:[1,0,0] neg_hi:[1,0,0]
    v_pk_fma_f32 v[10:11], v[146:147], v[124:125], v[10:11] op_sel_hi:[0,1,1] neg_lo:[1,0,0] neg_hi:[1,0,0]
    v_pk_mul_f32 v[8:9], v[8:9], v[146:147] op_sel:[0,1] op_sel_hi:[1,1]
    v_exp_f32 v8, v8
    v_exp_f32 v9, v9
    v_pk_fma_f32 v[0:1], v[0:1], v[148:149], v[148:149] op_sel_hi:[1,0,0]
    v_rcp_f32 v0, v0
    v_rcp_f32 v1, v1
    v_pk_fma_f32 v[4:5], v[4:5], v[148:149], v[148:149] op_sel_hi:[1,0,0]
    v_rcp_f32 v4, v4
    v_rcp_f32 v5, v5
    v_pk_fma_f32 v[8:9], v[8:9], v[148:149], v[148:149] op_sel_hi:[1,0,0]
    v_rcp_f32 v8, v8
    v_rcp_f32 v9, v9
    v_pk_mul_f32 v[0:1], v[0:1], v[2:3]
    v_cvt_pk_bf16_f32 v0, v0, v1
    ds_write_b32 v139, v0 offset:0
    v_pk_mul_f32 v[4:5], v[4:5], v[6:7]
    v_cvt_pk_bf16_f32 v4, v4, v5
    ds_write_b32 v140, v4 offset:0
    v_pk_mul_f32 v[8:9], v[8:9], v[10:11]
    v_cvt_pk_bf16_f32 v8, v8, v9
    ds_write_b32 v141, v8 offset:0
    v_and_b32 v148, 0xffff0000, v127
    v_lshlrev_b32 v146, 16, v127
    v_rcp_f32 v147, v148
    s_nop 0
    v_mul_f32 v147, s45, v147
    v_pk_fma_f32 v[12:13], v[146:147], v[114:115], v[12:13] op_sel_hi:[0,1,1] neg_lo:[1,0,0] neg_hi:[1,0,0]
    v_pk_fma_f32 v[14:15], v[146:147], v[116:117], v[14:15] op_sel_hi:[0,1,1] neg_lo:[1,0,0] neg_hi:[1,0,0]
    v_pk_mul_f32 v[12:13], v[12:13], v[146:147] op_sel:[0,1] op_sel_hi:[1,1]
    v_exp_f32 v12, v12
    v_exp_f32 v13, v13
    buffer_load_dwordx4 a[32:35], v135, s[8:11], s38 offen offset:0
    v_pk_fma_f32 v[16:17], v[146:147], v[118:119], v[16:17] op_sel_hi:[0,1,1] neg_lo:[1,0,0] neg_hi:[1,0,0]
    v_pk_fma_f32 v[18:19], v[146:147], v[120:121], v[18:19] op_sel_hi:[0,1,1] neg_lo:[1,0,0] neg_hi:[1,0,0]
    v_pk_mul_f32 v[16:17], v[16:17], v[146:147] op_sel:[0,1] op_sel_hi:[1,1]
    v_exp_f32 v16, v16
    v_exp_f32 v17, v17
    buffer_load_dwordx4 a[36:39], v135, s[8:11], s38 offen offset:1024
    v_pk_fma_f32 v[20:21], v[146:147], v[122:123], v[20:21] op_sel_hi:[0,1,1] neg_lo:[1,0,0] neg_hi:[1,0,0]
    v_pk_fma_f32 v[22:23], v[146:147], v[124:125], v[22:23] op_sel_hi:[0,1,1] neg_lo:[1,0,0] neg_hi:[1,0,0]
    v_pk_mul_f32 v[20:21], v[20:21], v[146:147] op_sel:[0,1] op_sel_hi:[1,1]
    v_exp_f32 v20, v20
    v_exp_f32 v21, v21
    v_pk_fma_f32 v[12:13], v[12:13], v[148:149], v[148:149] op_sel_hi:[1,0,0]
    v_rcp_f32 v12, v12
    v_rcp_f32 v13, v13
    v_pk_fma_f32 v[16:17], v[16:17], v[148:149], v[148:149] op_sel_hi:[1,0,0]
    v_rcp_f32 v16, v16
    v_rcp_f32 v17, v17
    v_pk_fma_f32 v[20:21], v[20:21], v[148:149], v[148:149] op_sel_hi:[1,0,0]
    v_rcp_f32 v20, v20
    v_rcp_f32 v21, v21
    v_pk_mul_f32 v[12:13], v[12:13], v[14:15]
    v_cvt_pk_bf16_f32 v12, v12, v13
    ds_write_b32 v139, v12 offset:128
    v_pk_mul_f32 v[16:17], v[16:17], v[18:19]
    v_cvt_pk_bf16_f32 v16, v16, v17
    ds_write_b32 v140, v16 offset:128
    v_pk_mul_f32 v[20:21], v[20:21], v[22:23]
    v_cvt_pk_bf16_f32 v20, v20, v21
    ds_write_b32 v141, v20 offset:128
    s_waitcnt lgkmcnt(0)
    s_barrier
    s_cmp_lg_u32 s29, 0
    s_cbranch_scc1 M_PUB1
    ds_read_b128 v[48:51], v144 offset:0
    ds_read_b128 v[52:55], v144 offset:1024
    ds_read_b128 v[56:59], v144 offset:2048
    s_waitcnt lgkmcnt(2)
    buffer_store_dwordx4 v[48:51], v135, s[8:11], s42 offen offset:0 sc1
    s_waitcnt lgkmcnt(1)
    buffer_store_dwordx4 v[52:55], v135, s[8:11], s42 offen offset:1024 sc1
    s_waitcnt lgkmcnt(0)
    buffer_store_dwordx4 v[56:59], v135, s[8:11], s42 offen offset:2048 sc1
M_PUB1:
    v_and_b32 v148, 0xffff0000, v128
    v_lshlrev_b32 v146, 16, v128
    v_rcp_f32 v147, v148
    s_nop 0
    v_mul_f32 v147, s45, v147
    v_pk_fma_f32 v[24:25], v[146:147], v[114:115], v[24:25] op_sel_hi:[0,1,1] neg_lo:[1,0,0] neg_hi:[1,0,0]
    v_pk_fma_f32 v[26:27], v[146:147], v[116:117], v[26:27] op_sel_hi:[0,1,1] neg_lo:[1,0,0] neg_hi:[1,0,0]
    v_pk_mul_f32 v[24:25], v[24:25], v[146:147] op_sel:[0,1] op_sel_hi:[1,1]
    v_exp_f32 v24, v24
    v_exp_f32 v25, v25
    buffer_load_dwordx4 a[40:43], v135, s[8:11], s38 offen offset:2048
    v_pk_fma_f32 v[28:29], v[146:147], v[118:119], v[28:29] op_sel_hi:[0,1,1] neg_lo:[1,0,0] neg_hi:[1,0,0]
    v_pk_fma_f32 v[30:31], v[146:147], v[120:121], v[30:31] op_sel_hi:[0,1,1] neg_lo:[1,0,0] neg_hi:[1,0,0]
    v_pk_mul_f32 v[28:29], v[28:29], v[146:147] op_sel:[0,1] op_sel_hi:[1,1]
    v_exp_f32 v28, v28
    v_exp_f32 v29, v29
    buffer_load_dwordx4 a[44:47], v135, s[8:11], s38 offen offset:3072
    s_add_u32 s38, s38, 0x1000
    v_pk_fma_f32 v[32:33], v[146:147], v[122:123], v[32:33] op_sel_hi:[0,1,1] neg_lo:[1,0,0] neg_hi:[1,0,0]
    v_pk_fma_f32 v[34:35], v[146:147], v[124:125], v[34:35] op_sel_hi:[0,1,1] neg_lo:[1,0,0] neg_hi:[1,0,0]
    v_pk_mul_f32 v[32:33], v[32:33], v[146:147] op_sel:[0,1] op_sel_hi:[1,1]
    v_exp_f32 v32, v32
    v_exp_f32 v33, v33
    v_pk_fma_f32 v[24:25], v[24:25], v[148:149], v[148:149] op_sel_hi:[1,0,0]
    v_rcp_f32 v24, v24
    v_rcp_f32 v25, v25
    v_pk_fma_f32 v[28:29], v[28:29], v[148:149], v[148:149] op_sel_hi:[1,0,0]
    v_rcp_f32 v28, v28
    v_rcp_f32 v29, v29
    v_pk_fma_f32 v[32:33], v[32:33], v[148:149], v[148:149] op_sel_hi:[1,0,0]
    v_rcp_f32 v32, v32
    v_rcp_f32 v33, v33
    v_pk_mul_f32 v[24:25], v[24:25], v[26:27]
    v_cvt_pk_bf16_f32 v24, v24, v25
    ds_write_b32 v139, v24 offset:6144
    v_pk_mul_f32 v[28:29], v[28:29], v[30:31]
    v_cvt_pk_bf16_f32 v28, v28, v29
    ds_write_b32 v140, v28 offset:6144
    v_pk_mul_f32 v[32:33], v[32:33], v[34:35]
    v_cvt_pk_bf16_f32 v32, v32, v33
    ds_write_b32 v141, v32 offset:6144
    v_and_b32 v148, 0xffff0000, v129
    v_lshlrev_b32 v146, 16, v129
    v_rcp_f32 v147, v148
    s_nop 0
    v_mul_f32 v147, s45, v147
    v_pk_fma_f32 v[36:37], v[146:147], v[114:115], v[36:37] op_sel_hi:[0,1,1] neg_lo:[1,0,0] neg_hi:[1,0,0]
    v_pk_fma_f32 v[38:39], v[146:147], v[116:117], v[38:39] op_sel_hi:[0,1,1] neg_lo:[1,0,0] neg_hi:[1,0,0]
    v_pk_mul_f32 v[36:37], v[36:37], v[146:147] op_sel:[0,1] op_sel_hi:[1,1]
    v_exp_f32 v36, v36
    v_exp_f32 v37, v37
    buffer_load_dwordx4 a[48:51], v135, s[8:11], s38 offen offset:0
    v_pk_fma_f32 v[40:41], v[146:147], v[118:119], v[40:41] op_sel_hi:[0,1,1] neg_lo:[1,0,0] neg_hi:[1,0,0]
    v_pk_fma_f32 v[42:43], v[146:147], v[120:121], v[42:43] op_sel_hi:[0,1,1] neg_lo:[1,0,0] neg_hi:[1,0,0]
    v_pk_mul_f32 v[40:41], v[40:41], v[146:147] op_sel:[0,1] op_sel_hi:[1,1]
    v_exp_f32 v40, v40
    v_exp_f32 v41, v41
    buffer_load_dwordx4 a[52:55], v135, s[8:11], s38 offen offset:1024
    v_pk_fma_f32 v[44:45], v[146:147], v[122:123], v[44:45] op_sel_hi:[0,1,1] neg_lo:[1,0,0] neg_hi:[1,0,0]
    v_pk_fma_f32 v[46:47], v[146:147], v[124:125], v[46:47] op_sel_hi:[0,1,1] neg_lo:[1,0,0] neg_hi:[1,0,0]
    v_pk_mul_f32 v[44:45], v[44:45], v[146:147] op_sel:[0,1] op_sel_hi:[1,1]
    v_exp_f32 v44, v44
    v_exp_f32 v45, v45
    v_pk_fma_f32 v[36:37], v[36:37], v[148:149], v[148:149] op_sel_hi:[1,0,0]
    v_rcp_f32 v36, v36
    v_rcp_f32 v37, v37
    v_pk_fma_f32 v[40:41], v[40:41], v[148:149], v[148:149] op_sel_hi:[1,0,0]
    v_rcp_f32 v40, v40
    v_rcp_f32 v41, v41
    v_pk_fma_f32 v[44:45], v[44:45], v[148:149], v[148:149] op_sel_hi:[1,0,0]
    v_rcp_f32 v44, v44
    v_rcp_f32 v45, v45
    v_pk_mul_f32 v[36:37], v[36:37], v[38:39]
    v_cvt_pk_bf16_f32 v36, v36, v37
    ds_write_b32 v139, v36 offset:6272
    v_pk_mul_f32 v[40:41], v[40:41], v[42:43]
    v_cvt_pk_bf16_f32 v40, v40, v41
    ds_write_b32 v140, v40 offset:6272
    v_pk_mul_f32 v[44:45], v[44:45], v[46:47]
    v_cvt_pk_bf16_f32 v44, v44, v45
    ds_write_b32 v141, v44 offset:6272
    s_waitcnt lgkmcnt(0)
    s_barrier
    s_cmp_eq_u32 s29, 0
    s_cbranch_scc1 M_PUB2
    ds_read_b128 v[48:51], v144 offset:0
    ds_read_b128 v[52:55], v144 offset:1024
    ds_read_b128 v[56:59], v144 offset:2048
    s_waitcnt lgkmcnt(2)
    buffer_store_dwordx4 v[48:51], v135, s[8:11], s42 offen offset:0 sc1
    s_waitcnt lgkmcnt(1)
    buffer_store_dwordx4 v[52:55], v135, s[8:11], s42 offen offset:1024 sc1
    s_waitcnt lgkmcnt(0)
    buffer_store_dwordx4 v[56:59], v135, s[8:11], s42 offen offset:2048 sc1
M_PUB2:
    s_lshl_b32 s26, s14, 4
    s_add_u32 s26, s26, s15
    s_lshl_b32 s26, s26, 7
    s_add_u32 s26, s26, s34
    v_mov_b32 v150, 1
    v_mov_b32 v151, 0
    s_waitcnt vmcnt(0)
    s_barrier
    s_cmp_lg_u32 s17, 0
    s_cbranch_scc1 M_NOFLAG
    s_mov_b64 exec, 1
    s_cmp_eq_u32 s54, 77
    s_cbranch_scc1 M_FLOC
    buffer_store_dword v150, v151, s[8:11], s26 offen sc1
    s_branch M_FEND
M_FLOC:
    buffer_store_dword v150, v151, s[8:11], s26 offen
M_FEND:
    s_mov_b64 exec, -1
M_NOFLAG:
    buffer_load_dwordx4 a[56:59], v135, s[8:11], s38 offen offset:2048
    buffer_load_dwordx4 a[60:63], v135, s[8:11], s38 offen offset:3072
    s_add_u32 s38, s38, 0x1000
    buffer_load_dwordx4 a[64:67], v135, s[8:11], s38 offen offset:0
    buffer_load_dwordx4 a[68:71], v135, s[8:11], s38 offen offset:1024
    buffer_load_dwordx4 a[72:75], v135, s[8:11], s38 offen offset:2048
    buffer_load_dwordx4 a[76:79], v135, s[8:11], s38 offen offset:3072
    s_add_u32 s38, s38, 0x1000
    buffer_load_dwordx4 a[80:83], v135, s[8:11], s38 offen offset:0
    buffer_load_dwordx4 a[84:87], v135, s[8:11], s38 offen offset:1024
M_SYNC:
    s_mov_b32 s55, 0
M_SYNC2:
    v_mov_b32 v160, 0
    s_lshl_b32 s26, s36, 2
    s_add_u32 s26, s26, s16
    s_mul_i32 s26, s26, 46080
    s_mul_i32 s27, s29, 22528
    s_add_u32 s26, s26, s27
    s_add_u32 s26, s26, s31
    s_lshl_b32 s27, s17, 11
    s_mul_i32 s28, s29, 0x3000
    v_add_u32 v104, s28, v135
    s_lshl_b32 s28, s29, 12
    s_add_u32 s28, s28, 0x1000
    v_add_u32 v105, s28, v135
    v_add_u32 v106, 0x10000, v104
    v_add_u32 v107, 0x10000, v105
    v_add_u32 v108, 0x20000, v104
    v_add_u32 v109, 0x20000, v105
    s_cmp_lg_u32 s17, 1
    s_cbranch_scc1 M_WAITB
    s_lshr_b32 s28, s36, 1
    s_lshl_b32 s28, s28, 11
    s_add_u32 s28, s28, s34
    v_min_u32 v154, 14, v136
    v_lshlrev_b32 v154, 7, v154
    s_mov_b32 s47, 0
M_POLL:
    buffer_load_dword v155, v154, s[8:11], s28 offen sc1
    s_waitcnt vmcnt(0)
    v_cmp_eq_u32 vcc, 0, v155
    s_nop 0
    s_cmp_eq_u64 vcc, 0
    s_cbranch_scc1 M_WAITB
    s_add_u32 s47, s47, 1
    s_cmp_lt_u32 s47, 1048576
    s_cbranch_scc1 M_POLL
M_WAITB:
    s_lshl_b32 s46, s37, 3
    s_add_u32 s46, s46, s17
    s_mul_i32 s46, s46, 2880
    s_mul_i32 s47, s36, 184320
    s_add_u32 s46, s46, s47
    s_add_u32 s46, s46, s31
    v_min_u32 v156, 44, v136
    v_lshlrev_b32 v156, 6, v156
    s_barrier
    s_add_u32 m0, s27, 0
    s_nop 0
    buffer_load_dwordx4 v135, s[8:11], s26 offen sc1 lds
    buffer_load_dwordx4 v135, s[8:11], s26 offen offset:1024 sc1 lds
    s_add_u32 s26, s26, 0x800
    s_add_u32 m0, s27, 16384
    s_nop 0
    buffer_load_dwordx4 v135, s[8:11], s26 offen sc1 lds
    buffer_load_dwordx4 v135, s[8:11], s26 offen offset:1024 sc1 lds
    s_add_u32 s26, s26, 0x800
    s_add_u32 m0, s27, 32768
    s_nop 0
    buffer_load_dwordx4 v135, s[8:11], s26 offen sc1 lds
    buffer_load_dwordx4 v135, s[8:11], s26 offen offset:1024 sc1 lds
    s_add_u32 s26, s26, 0x800
    s_add_u32 m0, s27, 49152
    s_nop 0
    buffer_load_dwordx4 v135, s[8:11], s26 offen sc1 lds
    buffer_load_dwordx4 v135, s[8:11], s26 offen offset:1024 sc1 lds
    s_add_u32 s26, s26, 0x800
    s_add_u32 m0, s27, 65536
    s_nop 0
    buffer_load_dwordx4 v135, s[8:11], s26 offen sc1 lds
    buffer_load_dwordx4 v135, s[8:11], s26 offen offset:1024 sc1 lds
    s_add_u32 s26, s26, 0x800
    s_waitcnt vmcnt(8)
    s_barrier
    ds_read_b128 v[16:19], v104 offset:0
    ds_read_b128 v[20:23], v104 offset:2048
    ds_read_b128 v[24:27], v105 offset:0
    ds_read_b128 v[28:31], v105 offset:2048
    ds_read_b128 v[32:35], v104 offset:1024
    ds_read_b128 v[36:39], v104 offset:3072
    ds_read_b128 v[40:43], v105 offset:1024
    ds_read_b128 v[44:47], v105 offset:3072
    s_waitcnt vmcnt(6)
    s_barrier
    s_waitcnt lgkmcnt(0)
    v_mfma_f32_16x16x32_bf16 v[0:3], v[16:19], a[0:3], 0
    ds_read_b128 v[48:51], v104 offset:16384
    v_mfma_f32_16x16x32_bf16 v[4:7], v[20:23], a[0:3], 0
    ds_read_b128 v[52:55], v104 offset:18432
    s_add_u32 m0, s27, 81920
    s_nop 0
    buffer_load_dwordx4 v135, s[8:11], s26 offen sc1 lds
    v_mfma_f32_16x16x32_bf16 v[8:11], v[24:27], a[0:3], 0
    ds_read_b128 v[56:59], v105 offset:16384
    v_mfma_f32_16x16x32_bf16 v[12:15], v[28:31], a[0:3], 0
    ds_read_b128 v[60:63], v105 offset:18432
    buffer_load_dwordx4 v135, s[8:11], s26 offen offset:1024 sc1 lds
    s_add_u32 s26, s26, 0x800
    v_mfma_f32_16x16x32_bf16 v[0:3], v[32:35], a[4:7], v[0:3]
    ds_read_b128 v[64:67], v104 offset:17408
    v_mfma_f32_16x16x32_bf16 v[4:7], v[36:39], a[4:7], v[4:7]
    ds_read_b128 v[68:71], v104 offset:19456
    v_mfma_f32_16x16x32_bf16 v[8:11], v[40:43], a[4:7], v[8:11]
    ds_read_b128 v[72:75], v105 offset:17408
    v_mfma_f32_16x16x32_bf16 v[12:15], v[44:47], a[4:7], v[12:15]
    ds_read_b128 v[76:79], v105 offset:19456
    s_waitcnt vmcnt(6)
    s_barrier
    s_waitcnt lgkmcnt(0)
    v_mfma_f32_16x16x32_bf16 v[0:3], v[48:51], a[8:11], v[0:3]
    ds_read_b128 v[16:19], v104 offset:32768
    v_mfma_f32_16x16x32_bf16 v[4:7], v[52:55], a[8:11], v[4:7]
    ds_read_b128 v[20:23], v104 offset:34816
    s_add_u32 m0, s27, 98304
    s_nop 0
    buffer_load_dwordx4 v135, s[8:11], s26 offen sc1 lds
    v_mfma_f32_16x16x32_bf16 v[8:11], v[56:59], a[8:11], v[8:11]
    ds_read_b128 v[24:27], v105 offset:32768
    v_mfma_f32_16x16x32_bf16 v[12:15], v[60:63], a[8:11], v[12:15]
    ds_read_b128 v[28:31], v105 offset:34816
    buffer_load_dwordx4 v135, s[8:11], s26 offen offset:1024 sc1 lds
    s_add_u32 s26, s26, 0x800
    v_mfma_f32_16x16x32_bf16 v[0:3], v[64:67], a[12:15], v[0:3]
    ds_read_b128 v[32:35], v104 offset:33792
    v_mfma_f32_16x16x32_bf16 v[4:7], v[68:71], a[12:15], v[4:7]
    ds_read_b128 v[36:39], v104 offset:35840
    v_mfma_f32_16x16x32_bf16 v[8:11], v[72:75], a[12:15], v[8:11]
    ds_read_b128 v[40:43], v105 offset:33792
    v_mfma_f32_16x16x32_bf16 v[12:15], v[76:79], a[12:15], v[12:15]
    ds_read_b128 v[44:47], v105 offset:35840
    s_waitcnt vmcnt(6)
    s_barrier
    s_waitcnt lgkmcnt(0)
    v_mfma_f32_16x16x32_bf16 v[0:3], v[16:19], a[16:19], v[0:3]
    ds_read_b128 v[48:51], v104 offset:49152
    v_mfma_f32_16x16x32_bf16 v[4:7], v[20:23], a[16:19], v[4:7]
    ds_read_b128 v[52:55], v104 offset:51200
    s_add_u32 m0, s27, 114688
    s_nop 0
    buffer_load_dwordx4 v135, s[8:11], s26 offen sc1 lds
    v_mfma_f32_16x16x32_bf16 v[8:11], v[24:27], a[16:19], v[8:11]
    ds_read_b128 v[56:59], v105 offset:49152
    v_mfma_f32_16x16x32_bf16 v[12:15], v[28:31], a[16:19], v[12:15]
    ds_read_b128 v[60:63], v105 offset:51200
    buffer_load_dwordx4 v135, s[8:11], s26 offen offset:1024 sc1 lds
    s_add_u32 s26, s26, 0x800
    v_mfma_f32_16x16x32_bf16 v[0:3], v[32:35], a[20:23], v[0:3]
    ds_read_b128 v[64:67], v104 offset:50176
    v_mfma_f32_16x16x32_bf16 v[4:7], v[36:39], a[20:23], v[4:7]
    ds_read_b128 v[68:71], v104 offset:52224
    v_mfma_f32_16x16x32_bf16 v[8:11], v[40:43], a[20:23], v[8:11]
    ds_read_b128 v[72:75], v105 offset:50176
    v_mfma_f32_16x16x32_bf16 v[12:15], v[44:47], a[20:23], v[12:15]
    ds_read_b128 v[76:79], v105 offset:52224
    s_waitcnt vmcnt(6)
    s_barrier
    s_waitcnt lgkmcnt(0)
    v_mfma_f32_16x16x32_bf16 v[0:3], v[48:51], a[24:27], v[0:3]
    ds_read_b128 v[16:19], v106 offset:0
    v_mfma_f32_16x16x32_bf16 v[4:7], v[52:55], a[24:27], v[4:7]
    ds_read_b128 v[20:23], v106 offset:2048
    s_add_u32 m0, s27, 131072
    s_nop 0
    buffer_load_dwordx4 v135, s[8:11], s26 offen sc1 lds
    v_mfma_f32_16x16x32_bf16 v[8:11], v[56:59], a[24:27], v[8:11]
    ds_read_b128 v[24:27], v107 offset:0
    v_mfma_f32_16x16x32_bf16 v[12:15], v[60:63], a[24:27], v[12:15]
    ds_read_b128 v[28:31], v107 offset:2048
    buffer_load_dwordx4 v135, s[8:11], s26 offen offset:1024 sc1 lds
    s_add_u32 s26, s26, 0x800
    v_mfma_f32_16x16x32_bf16 v[0:3], v[64:67], a[28:31], v[0:3]
    ds_read_b128 v[32:35], v106 offset:1024
    v_mfma_f32_16x16x32_bf16 v[4:7], v[68:71], a[28:31], v[4:7]
    ds_read_b128 v[36:39], v106 offset:3072
    v_mfma_f32_16x16x32_bf16 v[8:11], v[72:75], a[28:31], v[8:11]
    ds_read_b128 v[40:43], v107 offset:1024
    v_mfma_f32_16x16x32_bf16 v[12:15], v[76:79], a[28:31], v[12:15]
    ds_read_b128 v[44:47], v107 offset:3072
    s_waitcnt vmcnt(6)
    s_barrier
    s_waitcnt lgkmcnt(0)
    v_mfma_f32_16x16x32_bf16 v[0:3], v[16:19], a[32:35], v[0:3]
    ds_read_b128 v[48:51], v106 offset:16384
    v_mfma_f32_16x16x32_bf16 v[4:7], v[20:23], a[32:35], v[4:7]
    ds_read_b128 v[52:55], v106 offset:18432
    s_add_u32 m0, s27, 147456
    s_nop 0
    buffer_load_dwordx4 v135, s[8:11], s26 offen sc1 lds
    v_mfma_f32_16x16x32_bf16 v[8:11], v[24:27], a[32:35], v[8:11]
    ds_read_b128 v[56:59], v107 offset:16384
    v_mfma_f32_16x16x32_bf16 v[12:15], v[28:31], a[32:35], v[12:15]
    ds_read_b128 v[60:63], v107 offset:18432
    buffer_load_dwordx4 v135, s[8:11], s26 offen offset:1024 sc1 lds
    s_add_u32 s26, s26, 0x800
    v_mfma_f32_16x16x32_bf16 v[0:3], v[32:35], a[36:39], v[0:3]
    ds_read_b128 v[64:67], v106 offset:17408
    v_mfma_f32_16x16x32_bf16 v[4:7], v[36:39], a[36:39], v[4:7]
    ds_read_b128 v[68:71], v106 offset:19456
    v_mfma_f32_16x16x32_bf16 v[8:11], v[40:43], a[36:39], v[8:11]
    ds_read_b128 v[72:75], v107 offset:17408
    v_mfma_f32_16x16x32_bf16 v[12:15], v[44:47], a[36:39], v[12:15]
    ds_read_b128 v[76:79], v107 offset:19456
    s_waitcnt vmcnt(6)
    s_barrier
    s_waitcnt lgkmcnt(0)
    v_mfma_f32_16x16x32_bf16 v[0:3], v[48:51], a[40:43], v[0:3]
    ds_read_b128 v[16:19], v106 offset:32768
    v_mfma_f32_16x16x32_bf16 v[4:7], v[52:55], a[40:43], v[4:7]
    ds_read_b128 v[20:23], v106 offset:34816
    s_add_u32 m0, s27, 0
    s_nop 0
    buffer_load_dwordx4 v135, s[8:11], s26 offen sc1 lds
    v_mfma_f32_16x16x32_bf16 v[8:11], v[56:59], a[40:43], v[8:11]
    ds_read_b128 v[24:27], v107 offset:32768
    v_mfma_f32_16x16x32_bf16 v[12:15], v[60:63], a[40:43], v[12:15]
    ds_read_b128 v[28:31], v107 offset:34816
    buffer_load_dwordx4 v135, s[8:11], s26 offen offset:1024 sc1 lds
    s_add_u32 s26, s26, 0x800
    v_mfma_f32_16x16x32_bf16 v[0:3], v[64:67], a[44:47], v[0:3]
    ds_read_b128 v[32:35], v106 offset:33792
    v_mfma_f32_16x16x32_bf16 v[4:7], v[68:71], a[44:47], v[4:7]
    ds_read_b128 v[36:39], v106 offset:35840
    v_mfma_f32_16x16x32_bf16 v[8:11], v[72:75], a[44:47], v[8:11]
    ds_read_b128 v[40:43], v107 offset:33792
    v_mfma_f32_16x16x32_bf16 v[12:15], v[76:79], a[44:47], v[12:15]
    ds_read_b128 v[44:47], v107 offset:35840
    s_waitcnt vmcnt(6)
    s_barrier
    s_waitcnt lgkmcnt(0)
    v_mfma_f32_16x16x32_bf16 v[0:3], v[16:19], a[48:51], v[0:3]
    ds_read_b128 v[48:51], v106 offset:49152
    v_mfma_f32_16x16x32_bf16 v[4:7], v[20:23], a[48:51], v[4:7]
    ds_read_b128 v[52:55], v106 offset:51200
    v_mfma_f32_16x16x32_bf16 v[8:11], v[24:27], a[48:51], v[8:11]
    ds_read_b128 v[56:59], v107 offset:49152
    v_mfma_f32_16x16x32_bf16 v[12:15], v[28:31], a[48:51], v[12:15]
    ds_read_b128 v[60:63], v107 offset:51200
    v_mfma_f32_16x16x32_bf16 v[0:3], v[32:35], a[52:55], v[0:3]
    ds_read_b128 v[64:67], v106 offset:50176
    v_mfma_f32_16x16x32_bf16 v[4:7], v[36:39], a[52:55], v[4:7]
    ds_read_b128 v[68:71], v106 offset:52224
    v_mfma_f32_16x16x32_bf16 v[8:11], v[40:43], a[52:55], v[8:11]
    ds_read_b128 v[72:75], v107 offset:50176
    v_mfma_f32_16x16x32_bf16 v[12:15], v[44:47], a[52:55], v[12:15]
    ds_read_b128 v[76:79], v107 offset:52224
    s_waitcnt vmcnt(4)
    s_barrier
    s_waitcnt lgkmcnt(0)
    v_mfma_f32_16x16x32_bf16 v[0:3], v[48:51], a[56:59], v[0:3]
    ds_read_b128 v[16:19], v108 offset:0
    v_mfma_f32_16x16x32_bf16 v[4:7], v[52:55], a[56:59], v[4:7]
    ds_read_b128 v[20:23], v108 offset:2048
    v_mfma_f32_16x16x32_bf16 v[8:11], v[56:59], a[56:59], v[8:11]
    ds_read_b128 v[24:27], v109 offset:0
    v_mfma_f32_16x16x32_bf16 v[12:15], v[60:63], a[56:59], v[12:15]
    ds_read_b128 v[28:31], v109 offset:2048
    v_mfma_f32_16x16x32_bf16 v[0:3], v[64:67], a[60:63], v[0:3]
    ds_read_b128 v[32:35], v108 offset:1024
    v_mfma_f32_16x16x32_bf16 v[4:7], v[68:71], a[60:63], v[4:7]
    ds_read_b128 v[36:39], v108 offset:3072
    v_mfma_f32_16x16x32_bf16 v[8:11], v[72:75], a[60:63], v[8:11]
    ds_read_b128 v[40:43], v109 offset:1024
    v_mfma_f32_16x16x32_bf16 v[12:15], v[76:79], a[60:63], v[12:15]
    ds_read_b128 v[44:47], v109 offset:3072
    s_waitcnt vmcnt(2)
    s_barrier
    s_waitcnt lgkmcnt(0)
    v_mfma_f32_16x16x32_bf16 v[0:3], v[16:19], a[64:67], v[0:3]
    ds_read_b128 v[48:51], v108 offset:16384
    v_mfma_f32_16x16x32_bf16 v[4:7], v[20:23], a[64:67], v[4:7]
    ds_read_b128 v[52:55], v108 offset:18432
    v_mfma_f32_16x16x32_bf16 v[8:11], v[24:27], a[64:67], v[8:11]
    ds_read_b128 v[56:59], v109 offset:16384
    v_mfma_f32_16x16x32_bf16 v[12:15], v[28:31], a[64:67], v[12:15]
    ds_read_b128 v[60:63], v109 offset:18432
    v_mfma_f32_16x16x32_bf16 v[0:3], v[32:35], a[68:71], v[0:3]
    ds_read_b128 v[64:67], v108 offset:17408
    v_mfma_f32_16x16x32_bf16 v[4:7], v[36:39], a[68:71], v[4:7]
    ds_read_b128 v[68:71], v108 offset:19456
    v_mfma_f32_16x16x32_bf16 v[8:11], v[40:43], a[68:71], v[8:11]
    ds_read_b128 v[72:75], v109 offset:17408
    v_mfma_f32_16x16x32_bf16 v[12:15], v[44:47], a[68:71], v[12:15]
    ds_read_b128 v[76:79], v109 offset:19456
    s_waitcnt vmcnt(0)
    s_barrier
    s_waitcnt lgkmcnt(0)
    v_mfma_f32_16x16x32_bf16 v[0:3], v[48:51], a[72:75], v[0:3]
    ds_read_b128 v[16:19], v104 offset:0
    v_mfma_f32_16x16x32_bf16 v[4:7], v[52:55], a[72:75], v[4:7]
    ds_read_b128 v[20:23], v104 offset:2048
    v_mfma_f32_16x16x32_bf16 v[8:11], v[56:59], a[72:75], v[8:11]
    ds_read_b128 v[24:27], v105 offset:0
    v_mfma_f32_16x16x32_bf16 v[12:15], v[60:63], a[72:75], v[12:15]
    ds_read_b128 v[28:31], v105 offset:2048
    v_mfma_f32_16x16x32_bf16 v[0:3], v[64:67], a[76:79], v[0:3]
    ds_read_b128 v[32:35], v104 offset:1024
    v_mfma_f32_16x16x32_bf16 v[4:7], v[68:71], a[76:79], v[4:7]
    ds_read_b128 v[36:39], v104 offset:3072
    v_mfma_f32_16x16x32_bf16 v[8:11], v[72:75], a[76:79], v[8:11]
    ds_read_b128 v[40:43], v105 offset:1024
    v_mfma_f32_16x16x32_bf16 v[12:15], v[76:79], a[76:79], v[12:15]
    ds_read_b128 v[44:47], v105 offset:3072
    s_waitcnt lgkmcnt(0)
    v_mfma_f32_16x16x32_bf16 v[0:3], v[16:19], a[80:83], v[0:3]
    v_mfma_f32_16x16x32_bf16 v[4:7], v[20:23], a[80:83], v[4:7]
    v_mfma_f32_16x16x32_bf16 v[8:11], v[24:27], a[80:83], v[8:11]
    v_mfma_f32_16x16x32_bf16 v[12:15], v[28:31], a[80:83], v[12:15]
    v_mfma_f32_16x16x32_bf16 v[0:3], v[32:35], a[84:87], v[0:3]
    v_mfma_f32_16x16x32_bf16 v[4:7], v[36:39], a[84:87], v[4:7]
    v_mfma_f32_16x16x32_bf16 v[8:11], v[40:43], a[84:87], v[8:11]
    v_mfma_f32_16x16x32_bf16 v[12:15], v[44:47], a[84:87], v[12:15]
    s_lshl_b32 s26, s17, 11
    s_add_u32 s26, s26, 65536
    v_add_u32 v150, s26, v135
    s_xor_b32 s26, s26, 0x2000
    v_add_u32 v151, s26, v135
    v_lshlrev_b32 v32, 16, v130
    v_and_b32 v33, 0xffff0000, v130
    v_lshlrev_b32 v34, 16, v131
    v_and_b32 v35, 0xffff0000, v131
    v_lshlrev_b32 v36, 16, v132
    v_and_b32 v37, 0xffff0000, v132
    v_lshlrev_b32 v38, 16, v133
    v_and_b32 v39, 0xffff0000, v133
    ds_write_b128 v150, v[8:11]
    ds_write_b128 v150, v[12:15] offset:1024
    s_waitcnt lgkmcnt(0)
    s_barrier
    ds_read_b128 v[8:11], v151
    ds_read_b128 v[12:15], v151 offset:1024
    s_waitcnt lgkmcnt(0)
    v_pk_add_f32 v[0:1], v[0:1], v[8:9]
    v_cvt_pk_bf16_f32 v1, v0, v1
    v_lshlrev_b32 v0, 16, v1
    v_and_b32 v1, 0xffff0000, v1
    v_pk_add_f32 v[0:1], v[0:1], v[32:33]
    v_cvt_pk_bf16_f32 v16, v0, v1
    v_pk_add_f32 v[2:3], v[2:3], v[10:11]
    v_cvt_pk_bf16_f32 v3, v2, v3
    v_lshlrev_b32 v2, 16, v3
    v_and_b32 v3, 0xffff0000, v3
    v_pk_add_f32 v[2:3], v[2:3], v[34:35]
    v_cvt_pk_bf16_f32 v17, v2, v3
    v_pk_add_f32 v[4:5], v[4:5], v[12:13]
    v_cvt_pk_bf16_f32 v5, v4, v5
    v_lshlrev_b32 v4, 16, v5
    v_and_b32 v5, 0xffff0000, v5
    v_pk_add_f32 v[4:5], v[4:5], v[36:37]
    v_cvt_pk_bf16_f32 v18, v4, v5
    v_pk_add_f32 v[6:7], v[6:7], v[14:15]
    v_cvt_pk_bf16_f32 v7, v6, v7
    v_lshlrev_b32 v6, 16, v7
    v_and_b32 v7, 0xffff0000, v7
    v_pk_add_f32 v[6:7], v[6:7], v[38:39]
    v_cvt_pk_bf16_f32 v19, v6, v7
    s_cmp_lg_u32 s35, 0
    s_cbranch_scc1 M_FINAL
    s_add_u32 s40, s39, 16777216
    buffer_store_dwordx4 v[16:19], v142, s[8:11], s40 offen sc1
    v_lshlrev_b32 v48, 16, v16
    v_and_b32 v50, 0xffff0000, v16
    v_mul_f32 v49, v48, v48
    v_mul_f32 v51, v50, v50
    v_lshlrev_b32 v52, 16, v17
    v_and_b32 v54, 0xffff0000, v17
    v_mul_f32 v53, v52, v52
    v_mul_f32 v55, v54, v54
    v_lshlrev_b32 v56, 16, v18
    v_and_b32 v58, 0xffff0000, v18
    v_mul_f32 v57, v56, v56
    v_mul_f32 v59, v58, v58
    v_lshlrev_b32 v60, 16, v19
    v_and_b32 v62, 0xffff0000, v19
    v_mul_f32 v61, v60, v60
    v_mul_f32 v63, v62, v62
    v_add_f32_dpp v48, v48, v48 row_ror:8 row_mask:0xf bank_mask:0x3
    s_nop 1
    v_add_f32_dpp v48, v56, v56 row_ror:8 row_mask:0xf bank_mask:0xc
    v_add_f32_dpp v49, v49, v49 row_ror:8 row_mask:0xf bank_mask:0x3
    s_nop 1
    v_add_f32_dpp v49, v57, v57 row_ror:8 row_mask:0xf bank_mask:0xc
    v_add_f32_dpp v50, v50, v50 row_ror:8 row_mask:0xf bank_mask:0x3
    s_nop 1
    v_add_f32_dpp v50, v58, v58 row_ror:8 row_mask:0xf bank_mask:0xc
    v_add_f32_dpp v51, v51, v51 row_ror:8 row_mask:0xf bank_mask:0x3
    s_nop 1
    v_add_f32_dpp v51, v59, v59 row_ror:8 row_mask:0xf bank_mask:0xc
    v_add_f32_dpp v52, v52, v52 row_ror:8 row_mask:0xf bank_mask:0x3
    s_nop 1
    v_add_f32_dpp v52, v60, v60 row_ror:8 row_mask:0xf bank_mask:0xc
    v_add_f32_dpp v53, v53, v53 row_ror:8 row_mask:0xf bank_mask:0x3
    s_nop 1
    v_add_f32_dpp v53, v61, v61 row_ror:8 row_mask:0xf bank_mask:0xc
    v_add_f32_dpp v54, v54, v54 row_ror:8 row_mask:0xf bank_mask:0x3
    s_nop 1
    v_add_f32_dpp v54, v62, v62 row_ror:8 row_mask:0xf bank_mask:0xc
    v_add_f32_dpp v55, v55, v55 row_ror:8 row_mask:0xf bank_mask:0x3
    s_nop 1
    v_add_f32_dpp v55, v63, v63 row_ror:8 row_mask:0xf bank_mask:0xc
    v_add_f32_dpp v48, v48, v48 row_shl:4 row_mask:0xf bank_mask:0x5
    s_nop 1
    v_add_f32_dpp v48, v52, v52 row_shr:4 row_mask:0xf bank_mask:0xa
    v_add_f32_dpp v49, v49, v49 row_shl:4 row_mask:0xf bank_mask:0x5
    s_nop 1
    v_add_f32_dpp v49, v53, v53 row_shr:4 row_mask:0xf bank_mask:0xa
    v_add_f32_dpp v50, v50, v50 row_shl:4 row_mask:0xf bank_mask:0x5
    s_nop 1
    v_add_f32_dpp v50, v54, v54 row_shr:4 row_mask:0xf bank_mask:0xa
    v_add_f32_dpp v51, v51, v51 row_shl:4 row_mask:0xf bank_mask:0x5
    s_nop 1
    v_add_f32_dpp v51, v55, v55 row_shr:4 row_mask:0xf bank_mask:0xa
    v_add_f32_dpp v48, v48, v48 quad_perm:[1,0,3,2] row_mask:0xf bank_mask:0xf
    v_add_f32_dpp v49, v49, v49 quad_perm:[1,0,3,2] row_mask:0xf bank_mask:0xf
    v_add_f32_dpp v50, v50, v50 quad_perm:[1,0,3,2] row_mask:0xf bank_mask:0xf
    v_add_f32_dpp v51, v51, v51 quad_perm:[1,0,3,2] row_mask:0xf bank_mask:0xf
    v_add_f32_dpp v48, v48, v48 quad_perm:[2,3,0,1] row_mask:0xf bank_mask:0xf
    v_add_f32_dpp v49, v49, v49 quad_perm:[2,3,0,1] row_mask:0xf bank_mask:0xf
    v_add_f32_dpp v50, v50, v50 quad_perm:[2,3,0,1] row_mask:0xf bank_mask:0xf
    v_add_f32_dpp v51, v51, v51 quad_perm:[2,3,0,1] row_mask:0xf bank_mask:0xf
    v_and_b32 v150, 3, v137
    v_cmp_eq_u32 s[48:49], 1, v150
    v_cmp_eq_u32 s[50:51], 2, v150
    v_cmp_eq_u32 s[52:53], 3, v150
    v_lshrrev_b32 v151, 2, v137
    v_lshlrev_b32 v151, 7, v151
    v_lshl_add_u32 v151, v138, 4, v151
    v_lshl_add_u32 v151, v150, 2, v151
    s_lshl_b32 s26, s16, 9
    s_lshl_b32 s27, s29, 6
    s_add_u32 s26, s26, s27
    s_add_u32 s26, s26, 98304
    v_add_u32 v151, s26, v151
    v_cndmask_b32 v48, v48, v49, s[48:49]
    v_cndmask_b32 v48, v48, v50, s[50:51]
    v_cndmask_b32 v48, v48, v51, s[52:53]
    ds_write_b32 v151, v48
    s_lshl_b32 s26, s17, 8
    s_add_u32 s26, s26, 98304
    v_lshl_add_u32 v152, v136, 2, s26
    v_lshrrev_b32 v153, 5, v136
    v_lshlrev_b32 v153, 12, v153
    v_and_b32 v154, 31, v136
    v_lshl_add_u32 v153, v154, 2, v153
    s_lshl_b32 s26, s36, 7
    s_lshl_b32 s27, s17, 13
    s_add_u32 s26, s26, s27
    s_add_u32 s26, s26, 16384
    s_waitcnt lgkmcnt(0)
    s_barrier
    s_cmp_ge_u32 s17, 2
    s_cbranch_scc1 M_NOAT
    ds_read_b32 v48, v152
    ds_read_b32 v49, v152 offset:512
    ds_read_b32 v50, v152 offset:1024
    ds_read_b32 v51, v152 offset:1536
    s_waitcnt lgkmcnt(0)
    v_add_f32 v48, v48, v49
    v_add_f32 v50, v50, v51
    v_add_f32 v48, v48, v50
    buffer_atomic_add_f32 v48, v153, s[8:11], s26 offen
M_NOAT:
    s_endpgm
M_FINAL:
    s_mov_b32 s48, s6
    s_and_b32 s49, s7, 0xffff
    s_mov_b32 s50, 0x200000
    s_mov_b32 s51, 0x20000
    s_lshl_b32 s26, s16, 4
    v_add_u32 v150, s26, v137
    v_mul_u32_u24 v150, 144, v150
    v_lshl_add_u32 v150, v138, 4, v150
    s_lshl_b32 s26, s29, 6
    s_add_u32 s26, s26, 98304
    v_add_u32 v150, s26, v150
    ds_write_b128 v150, v[16:19]
    v_lshrrev_b32 v151, 2, v137
    v_lshl_add_u32 v151, v138, 3, v151
    v_mul_u32_u24 v151, 144, v151
    v_and_b32 v152, 3, v137
    v_lshl_add_u32 v151, v152, 3, v151
    s_lshl_b32 s26, s16, 5
    s_mul_i32 s27, s29, 4608
    s_add_u32 s26, s26, s27
    s_add_u32 s26, s26, 98304
    v_add_u32 v151, s26, v151
    v_lshlrev_b32 v152, 10, v137
    v_lshl_add_u32 v152, v138, 4, v152
    s_lshl_b32 s26, s36, 2
    s_add_u32 s26, s26, s16
    s_lshl_b32 s26, s26, 14
    s_lshl_b32 s27, s37, 7
    s_add_u32 s26, s26, s27
    s_lshl_b32 s27, s29, 6
    s_add_u32 s26, s26, s27
    s_waitcnt lgkmcnt(0)
    s_barrier
    ds_read_b64_tr_b16 v[32:33], v151
    ds_read_b64_tr_b16 v[34:35], v151 offset:576
    s_waitcnt lgkmcnt(0)
    buffer_store_dwordx4 v[32:35], v152, s[48:51], s26 offen
M_END:
    s_endpgm
M_STATS:
    s_mov_b32 s47, 0
M_SL1:
    s_mov_b32 m0, s19
    s_add_u32 s19, s19, 0x2000
    buffer_load_dwordx4 v134, s[8:11], s18 offen lds
    s_add_u32 s18, s18, 0x2000
    s_mov_b32 m0, s19
    s_add_u32 s19, s19, 0x2000
    buffer_load_dwordx4 v134, s[8:11], s18 offen lds
    s_add_u32 s18, s18, 0x2000
    s_add_u32 s47, s47, 1
    s_cmp_lt_u32 s47, 8
    s_cbranch_scc1 M_SL1
    v_xor_b32 v153, s17, v151
    v_lshl_add_u32 v104, v153, 5, v152
    v_mov_b32 v0, 0
    v_mov_b32 v1, 0
    v_mov_b32 v2, 0
    v_mov_b32 v3, 0
    v_mov_b32 v4, 0
    v_mov_b32 v5, 0
    v_mov_b32 v6, 0
    v_mov_b32 v7, 0
    v_mov_b32 v16, 0x3f803f80
    v_mov_b32 v17, 0x3f803f80
    v_mov_b32 v18, 0x3f803f80
    v_mov_b32 v19, 0x3f803f80
    s_mov_b32 s47, 0
    s_waitcnt vmcnt(0)
    s_barrier
M_SL2:
    ds_read_b64_tr_b16 v[48:49], v104 offset:0
    ds_read_b64_tr_b16 v[50:51], v104 offset:4096
    ds_read_b64_tr_b16 v[52:53], v104 offset:8192
    ds_read_b64_tr_b16 v[54:55], v104 offset:12288
    ds_read_b64_tr_b16 v[56:57], v104 offset:16384
    ds_read_b64_tr_b16 v[58:59], v104 offset:20480
    ds_read_b64_tr_b16 v[60:61], v104 offset:24576
    ds_read_b64_tr_b16 v[62:63], v104 offset:28672
    ds_read_b64_tr_b16 v[64:65], v104 offset:32768
    ds_read_b64_tr_b16 v[66:67], v104 offset:36864
    ds_read_b64_tr_b16 v[68:69], v104 offset:40960
    ds_read_b64_tr_b16 v[70:71], v104 offset:45056
    ds_read_b64_tr_b16 v[72:73], v104 offset:49152
    ds_read_b64_tr_b16 v[74:75], v104 offset:53248
    s_waitcnt lgkmcnt(12)
    ds_read_b64_tr_b16 v[76:77], v104 offset:57344
    ds_read_b64_tr_b16 v[78:79], v104 offset:61440
    v_add_u32 v104, 0x10000, v104
    s_waitcnt lgkmcnt(14)
    v_mfma_f32_16x16x32_bf16 v[0:3], v[48:51], v[48:51], v[0:3]
    v_mfma_f32_16x16x32_bf16 v[4:7], v[16:19], v[48:51], v[4:7]
    s_waitcnt lgkmcnt(12)
    v_mfma_f32_16x16x32_bf16 v[0:3], v[52:55], v[52:55], v[0:3]
    v_mfma_f32_16x16x32_bf16 v[4:7], v[16:19], v[52:55], v[4:7]
    s_waitcnt lgkmcnt(10)
    v_mfma_f32_16x16x32_bf16 v[0:3], v[56:59], v[56:59], v[0:3]
    v_mfma_f32_16x16x32_bf16 v[4:7], v[16:19], v[56:59], v[4:7]
    s_waitcnt lgkmcnt(8)
    v_mfma_f32_16x16x32_bf16 v[0:3], v[60:63], v[60:63], v[0:3]
    v_mfma_f32_16x16x32_bf16 v[4:7], v[16:19], v[60:63], v[4:7]
    s_waitcnt lgkmcnt(6)
    v_mfma_f32_16x16x32_bf16 v[0:3], v[64:67], v[64:67], v[0:3]
    v_mfma_f32_16x16x32_bf16 v[4:7], v[16:19], v[64:67], v[4:7]
    s_waitcnt lgkmcnt(4)
    v_mfma_f32_16x16x32_bf16 v[0:3], v[68:71], v[68:71], v[0:3]
    v_mfma_f32_16x16x32_bf16 v[4:7], v[16:19], v[68:71], v[4:7]
    s_waitcnt lgkmcnt(2)
    v_mfma_f32_16x16x32_bf16 v[0:3], v[72:75], v[72:75], v[0:3]
    v_mfma_f32_16x16x32_bf16 v[4:7], v[16:19], v[72:75], v[4:7]
    s_waitcnt lgkmcnt(0)
    v_mfma_f32_16x16x32_bf16 v[0:3], v[76:79], v[76:79], v[0:3]
    v_mfma_f32_16x16x32_bf16 v[4:7], v[16:19], v[76:79], v[4:7]
    s_add_u32 s47, s47, 1
    s_cmp_lt_u32 s47, 2
    s_cbranch_scc1 M_SL2
    v_and_b32 v150, 3, v137
    v_cmp_eq_u32 s[48:49], 1, v150
    v_cmp_eq_u32 s[50:51], 2, v150
    v_cmp_eq_u32 s[52:53], 3, v150
    v_lshrrev_b32 v150, 2, v137
    v_cmp_eq_u32 s[54:55], v150, v138
    v_cndmask_b32 v0, v0, v1, s[48:49]
    v_cndmask_b32 v0, v0, v2, s[50:51]
    v_cndmask_b32 v5, v0, v3, s[52:53]
    v_mov_b32 v12, v4
    v_mov_b32 v13, v5
    v_mul_f32 v4, s43, v4
    v_mul_f32 v5, s43, v5
    v_fma_f32 v5, -v4, v4, v5
    v_max_f32 v5, 0, v5
    v_cvt_pk_bf16_f32 v5, v4, v5
    v_lshlrev_b32 v4, 16, v5
    v_and_b32 v5, 0xffff0000, v5
    v_add_f32 v5, s44, v5
    v_mul_f32 v12, s43, v12
    v_mul_f32 v13, s43, v13
    v_fma_f32 v13, -v12, v12, v13
    v_max_f32 v13, 0, v13
    v_cvt_pk_bf16_f32 v13, v12, v13
    v_lshlrev_b32 v12, 16, v13
    v_and_b32 v13, 0xffff0000, v13
    v_add_f32 v13, s44, v13
    v_cvt_pk_bf16_f32 v150, v5, v13
    v_lshlrev_b32 v5, 16, v150
    v_and_b32 v13, 0xffff0000, v150
    v_sqrt_f32 v5, v5
    v_sqrt_f32 v13, v13
    s_nop 0
    v_cvt_pk_bf16_f32 v150, v5, v13
    v_lshlrev_b32 v6, 16, v150
    v_and_b32 v14, 0xffff0000, v150
    v_rcp_f32 v5, v6
    v_rcp_f32 v13, v14
    v_lshrrev_b32 v4, 16, v4
    v_or_b32 v4, v4, v6
    v_lshlrev_b32 v143, 2, v137
    s_lshl_b32 s41, s14, 9
    s_lshl_b32 s26, s17, 6
    s_add_u32 s41, s41, s26
    s_add_u32 s41, s41, s33
    s_mov_b64 exec, s[54:55]
    buffer_store_dword v4, v143, s[8:11], s41 offen sc1
    s_mov_b64 exec, -1
    buffer_load_dwordx4 v[130:133], v159, s[8:11], s40 offen
    buffer_load_dwordx4 a[0:3], v135, s[8:11], s38 offen offset:0
    buffer_load_dwordx4 a[4:7], v135, s[8:11], s38 offen offset:1024
    buffer_load_dwordx4 a[8:11], v135, s[8:11], s38 offen offset:2048
    buffer_load_dwordx4 a[12:15], v135, s[8:11], s38 offen offset:3072
    s_add_u32 s38, s38, 0x1000
    buffer_load_dwordx4 a[16:19], v135, s[8:11], s38 offen offset:0
    buffer_load_dwordx4 a[20:23], v135, s[8:11], s38 offen offset:1024
    buffer_load_dwordx4 a[24:27], v135, s[8:11], s38 offen offset:2048
    buffer_load_dwordx4 a[28:31], v135, s[8:11], s38 offen offset:3072
    s_add_u32 s38, s38, 0x1000
    buffer_load_dwordx4 a[32:35], v135, s[8:11], s38 offen offset:0
    buffer_load_dwordx4 a[36:39], v135, s[8:11], s38 offen offset:1024
    buffer_load_dwordx4 a[40:43], v135, s[8:11], s38 offen offset:2048
    buffer_load_dwordx4 a[44:47], v135, s[8:11], s38 offen offset:3072
    s_add_u32 s38, s38, 0x1000
    buffer_load_dwordx4 a[48:51], v135, s[8:11], s38 offen offset:0
    buffer_load_dwordx4 a[52:55], v135, s[8:11], s38 offen offset:1024
    buffer_load_dwordx4 a[56:59], v135, s[8:11], s38 offen offset:2048
    buffer_load_dwordx4 a[60:63], v135, s[8:11], s38 offen offset:3072
    s_add_u32 s38, s38, 0x1000
    buffer_load_dwordx4 a[64:67], v135, s[8:11], s38 offen offset:0
    buffer_load_dwordx4 a[68:71], v135, s[8:11], s38 offen offset:1024
    buffer_load_dwordx4 a[72:75], v135, s[8:11], s38 offen offset:2048
    buffer_load_dwordx4 a[76:79], v135, s[8:11], s38 offen offset:3072
    s_add_u32 s38, s38, 0x1000
    buffer_load_dwordx4 a[80:83], v135, s[8:11], s38 offen offset:0
    buffer_load_dwordx4 a[84:87], v135, s[8:11], s38 offen offset:1024
    s_barrier
    s_branch M_SYNC
    .p2align 8
mlpb_kernel:
    s_mov_b32 s30, 19136512
    s_mov_b32 s31, 21233664
    s_mov_b32 s33, 73728
    s_mov_b32 s34, 163840
    s_mov_b32 s35, 1
    s_mov_b32 s56, 82944
    s_branch M_BODY
TEXT_END:

.section .rodata,"a"
.p2align 6
.amdhsa_kernel f1_kernel
  .amdhsa_next_free_vgpr 168
  .amdhsa_next_free_sgpr 60
  .amdhsa_accum_offset 168
  .amdhsa_group_segment_fixed_size 0
  .amdhsa_kernarg_size 112
  .amdhsa_user_sgpr_count 2
  .amdhsa_user_sgpr_kernarg_segment_ptr 1
  .amdhsa_system_sgpr_workgroup_id_x 1
  .amdhsa_float_denorm_mode_32 3
.end_amdhsa_kernel

.section .rodata,"a"
.p2align 6
.amdhsa_kernel conv2_kernel
  .amdhsa_next_free_vgpr 168
  .amdhsa_next_free_sgpr 60
  .amdhsa_accum_offset 168
  .amdhsa_group_segment_fixed_size 0
  .amdhsa_kernarg_size 112
  .amdhsa_user_sgpr_count 2
  .amdhsa_user_sgpr_kernarg_segment_ptr 1
  .amdhsa_system_sgpr_workgroup_id_x 1
  .amdhsa_float_denorm_mode_32 3
.end_amdhsa_kernel

.section .rodata,"a"
.p2align 6
.amdhsa_kernel mlpa_kernel
  .amdhsa_next_free_vgpr 256
  .amdhsa_next_free_sgpr 66
  .amdhsa_accum_offset 168
  .amdhsa_group_segment_fixed_size 0
  .amdhsa_kernarg_size 112
  .amdhsa_user_sgpr_count 2
  .amdhsa_user_sgpr_kernarg_segment_ptr 1
  .amdhsa_system_sgpr_workgroup_id_x 1
  .amdhsa_float_denorm_mode_32 3
.end_amdhsa_kernel

.section .rodata,"a"
.p2align 6
.amdhsa_kernel mlpb_kernel
  .amdhsa_next_free_vgpr 256
  .amdhsa_next_free_sgpr 66
  .amdhsa_accum_offset 168
  .amdhsa_group_segment_fixed_size 0
  .amdhsa_kernarg_size 112
  .amdhsa_user_sgpr_count 2
  .amdhsa_user_sgpr_kernarg_segment_ptr 1
  .amdhsa_system_sgpr_workgroup_id_x 1
  .amdhsa_float_denorm_mode_32 3
.end_amdhsa_kernel
```
